```python
import torch

def _softmax(x, axis=-1):
    return torch.softmax(x, dim=axis)
def _gelu(x):
    return torch.nn.functional.gelu(x, approximate="tanh")
def _silu(x):
    return torch.nn.functional.silu(x)
def _sigmoid(x):
    return torch.sigmoid(x)
def _layernorm(x, axis=-1, eps=1e-5):
    m = x.mean(dim=axis, keepdim=True)
    v = x.var(dim=axis, keepdim=True, unbiased=False)
    return (x - m) / torch.sqrt(v + eps)
def _scatter_add(tgt, idx, src, axis=0):
    return tgt.clone().index_add_(axis, idx, src)
def _segment_sum(src, seg, n):
    out = torch.zeros((n,) + src.shape[1:], dtype=src.dtype)
    return out.index_add_(0, seg, src)
def _pad(x, pw):
    flat = tuple(v for pair in reversed(pw) for v in pair)
    return torch.nn.functional.pad(x, flat)

kernel_name = 'interleave_layers__sliding_block_cached__glu_gated_bilinear__decode'

def setup_inputs():

    _w = (lambda a: (lambda t: t.to(torch.bfloat16) if t.is_floating_point() else t)(torch.as_tensor(a)))
    def _A_setup():
        B, Sq, D = 1, 1, 640
        Hq, Hkv, Sk, Dh = 32, 32, 8192, 192
        assert Hq % Hkv == 0, (Hq, Hkv)
        return {
            "x": _w((lambda *s: torch.randn(*s, dtype=torch.bfloat16) * 0.05)(B, Sq, D)),
            "k_cache": _w((lambda *s: torch.randn(*s, dtype=torch.bfloat16) * 0.8)(B, Hkv, Sk, Dh)),
            "v_cache": _w((lambda *s: torch.randn(*s, dtype=torch.bfloat16) * 0.8)(B, Hkv, Sk, Dh)),
            "wq": _w((lambda *s: torch.randn(*s, dtype=torch.bfloat16) * 0.8)(D, Hq * Dh) * (D ** -0.5)),
            "wo": _w((lambda *s: torch.randn(*s, dtype=torch.bfloat16) * 0.8)(Hq * Dh, D) * ((Hq * Dh) ** -0.5)),
        }
    _A_in = _A_setup()

    def _B_setup():
        B, S, D, F = 1, 1, 640, 1536
        return {
            "x": _w((lambda *s: torch.randn(*s, dtype=torch.bfloat16) * 0.05)(B, S, D)),
            "w_gate": _w((lambda *s: torch.randn(*s, dtype=torch.bfloat16) * 0.4)(D, F) * (D ** -0.5)),
            "w_up": _w((lambda *s: torch.randn(*s, dtype=torch.bfloat16) * 0.4)(D, F) * (D ** -0.5)),
            "w_down": _w((lambda *s: torch.randn(*s, dtype=torch.bfloat16) * 0.4)(F, D) * (F ** -0.5)),
        }
    _B_in = _B_setup()

    return {
        "A_x": _A_in["x"],
        "A_k_cache": _A_in["k_cache"],
        "A_v_cache": _A_in["v_cache"],
        "A_wq": _A_in["wq"],
        "A_wo": _A_in["wo"],
        "B_x": _B_in["x"],
        "B_w_gate": _B_in["w_gate"],
        "B_w_up": _B_in["w_up"],
        "B_w_down": _B_in["w_down"],
    }

def reference(A_x, A_k_cache, A_v_cache, A_wq, A_wo, B_x, B_w_gate, B_w_up, B_w_down):
    def _A_ref(x, k_cache, v_cache, wq, wo):
        B, Sq, D = x.shape
        Hq, Dh = 32, 192
        Hkv, Sk = k_cache.shape[1], k_cache.shape[2]
        W = min(4096, max(256, Sk // 4))
        rep = Hq // Hkv
        q = (lambda x, *d: x.permute(*d))((x @ wq).reshape(B, Sq, Hq, Dh), 0, 2, 1, 3)
        k = (lambda x, n, axis: torch.repeat_interleave(x, n, dim=axis))(k_cache[:, :, Sk - W:, :], rep, axis=1)
        v = (lambda x, n, axis: torch.repeat_interleave(x, n, dim=axis))(v_cache[:, :, Sk - W:, :], rep, axis=1)
        scores = torch.einsum("bhqd,bhkd->bhqk", q, k) * (Dh ** -0.5)
        p = _softmax(scores, axis=-1)
        o = torch.einsum("bhqk,bhkd->bhqd", p, v)
        return (lambda x, *d: x.permute(*d))(o, 0, 2, 1, 3).reshape(B, Sq, Hq * Dh) @ wo

    def _B_ref(x, w_gate, w_up, w_down):
        g = torch.einsum("bsd,df->bsf", x, w_gate)
        u = torch.einsum("bsd,df->bsf", x, w_up)
        h = g * u
        return torch.einsum("bsf,fd->bsd", h, w_down)

    x = A_x
    x = x + _A_ref(_layernorm(x, axis=-1), A_k_cache, A_v_cache, A_wq, A_wo)
    x = x + _B_ref(_layernorm(x, axis=-1), B_w_gate, B_w_up, B_w_down)
    x = x + _A_ref(_layernorm(x, axis=-1), A_k_cache, A_v_cache, A_wq, A_wo)
    x = x + _B_ref(_layernorm(x, axis=-1), B_w_gate, B_w_up, B_w_down)
    return x
```

```asm
; @launch grid=(256,1,1) block=(512,1,1) lds=22528
.amdgcn_target "amdgcn-amd-amdhsa--gfx950"
.text
.globl interleave_layers__sliding_block_cached__glu_gated_bilinear__decode_kernel
.p2align 8
.type interleave_layers__sliding_block_cached__glu_gated_bilinear__decode_kernel,@function
interleave_layers__sliding_block_cached__glu_gated_bilinear__decode_kernel:
    s_cmp_ge_u32 s2, 256
    s_cbranch_scc1 L_END
    s_load_dwordx16 s[4:19], s[0:1], 0
    s_load_dwordx8 s[20:27], s[0:1], 64
    v_and_b32 v1, 63, v0
    v_lshrrev_b32 v2, 6, v0
    s_and_b32 s28, s2, 7
    s_lshr_b32 s29, s2, 3
    v_readfirstlane_b32 s30, v2
    s_mov_b32 s31, 0
    s_mov_b32 s79, 0
    s_max_u32 s33, s29, 2
    s_sub_u32 s33, s33, 2
    s_mul_i32 s72, s33, 43
    s_lshr_b32 s72, s72, 8
    s_mul_i32 s32, s72, 6
    s_sub_u32 s73, s33, s32
    s_max_u32 s32, s29, 12
    s_sub_u32 s32, s32, 12
    s_mul_i32 s74, s32, 52
    s_lshr_b32 s74, s74, 8
    s_mul_i32 s33, s74, 5
    s_sub_u32 s75, s32, s33
    s_min_u32 s32, s29, 14
    s_mul_i32 s76, s32, 52
    s_lshr_b32 s76, s76, 8
    s_mul_i32 s33, s76, 5
    s_sub_u32 s77, s32, s33
    s_and_b32 s78, s30, 3
    s_waitcnt lgkmcnt(0)
    s_mov_b32 s36, s26
    s_and_b32 s37, s27, 0xffff
    s_mov_b32 s38, 0x400000
    s_mov_b32 s39, 0x20000
    v_mov_b32 v62, 0xff
    v_mov_b32 v63, 0xffff
    s_cmp_ge_u32 s30, 4
    s_cbranch_scc1 L_W
    s_lshr_b32 s32, s29, 3
    s_lshl_b32 s33, s28, 2
    s_add_u32 s32, s32, s33
    s_mul_i32 s32, s32, 3145728
    s_and_b32 s33, s29, 7
    s_mul_i32 s33, s33, 98304
    s_add_u32 s32, s32, s33
    s_mul_i32 s33, s78, 24576
    s_add_u32 s32, s32, s33
    s_add_u32 s32, s32, 2359296
    s_add_u32 s40, s6, s32
    s_addc_u32 s41, s7, 0
    s_and_b32 s41, s41, 0xffff
    s_mov_b32 s42, 0x6000
    s_mov_b32 s43, 0x20000
    s_add_u32 s44, s8, s32
    s_addc_u32 s45, s9, 0
    s_and_b32 s45, s45, 0xffff
    s_mov_b32 s46, 0x6000
    s_mov_b32 s47, 0x20000
    v_lshrrev_b32 v52, 3, v1
    v_and_b32 v53, 7, v1
    v_mul_u32_u24 v2, 0x180, v52
    v_lshl_add_u32 v2, v53, 4, v2
    s_mov_b32 s71, 0
    v_and_b32 v54, 1, v1
    v_lshlrev_b32 v54, 4, v54
    v_mov_b32 v55, 0xffff
    v_lshlrev_b32 v55, v54, v55
    v_bfe_u32 v56, v1, 1, 2
    v_cmp_eq_u32 vcc, 0, v56
    s_nop 1
    v_cndmask_b32 v8, 0, v55, vcc
    v_cmp_eq_u32 vcc, 1, v56
    s_nop 1
    v_cndmask_b32 v9, 0, v55, vcc
    v_cmp_eq_u32 vcc, 2, v56
    s_nop 1
    v_cndmask_b32 v10, 0, v55, vcc
    v_cmp_eq_u32 vcc, 3, v56
    s_nop 1
    v_cndmask_b32 v11, 0, v55, vcc
    v_and_b32 v54, 15, v1
    v_lshlrev_b32 v4, 5, v54
    v_bfe_u32 v55, v1, 4, 1
    v_lshl_add_u32 v4, v55, 4, v4
    v_lshlrev_b32 v5, 4, v1
    v_lshlrev_b32 v6, 4, v53
    v_lshlrev_b32 v7, 5, v53
    v_lshl_add_u32 v7, v55, 4, v7
    v_bfe_u32 v54, v1, 3, 1
    v_lshl_add_u32 v7, v54, 3, v7
    v_lshrrev_b32 v54, 5, v1
    v_lshl_add_u32 v7, v54, 2, v7
    s_lshl_b32 s32, s78, 10
    v_add_u32 v7, s32, v7
    v_add_u32 v3, s32, v5
    s_mov_b32 s70, 0x3dd53b95
    s_lshl_b32 s32, s28, 5
    s_add_u32 s32, s32, s29
    s_lshl_b32 s33, s32, 2
    s_add_u32 s89, s33, 1383680
    s_add_u32 s90, s33, 1385728
    s_lshl_b32 s32, s32, 10
    s_add_u32 s84, s32, 377088
    s_lshl_b32 s32, s28, 2
    s_add_u32 s32, s32, s74
    s_mul_i32 s32, s32, 2560
    s_lshl_b32 s33, s75, 9
    s_add_u32 s32, s32, s33
    s_add_u32 s85, s32, 901376
    s_mul_i32 s32, s28, 3
    s_add_u32 s32, s32, s76
    s_mul_i32 s33, s32, 2560
    s_lshl_b32 s35, s77, 9
    s_add_u32 s33, s33, s35
    s_add_u32 s88, s33, 1255680
    s_lshl_b32 s33, s32, 7
    s_lshl_b32 s35, s77, 4
    s_add_u32 s33, s33, s35
    s_add_u32 s87, s33, 1249536
    s_mul_i32 s32, s32, 5
    s_add_u32 s32, s32, s77
    s_lshl_b32 s32, s32, 9
    s_add_u32 s86, s32, 1065216
    s_barrier
    s_load_dword s93, s[26:27], 0
    s_add_u32 s35, s71, 0
    s_and_b32 s35, s35, 7
    s_mul_i32 s35, s35, 3072
    buffer_load_dwordx4 v[64:67], v2, s[40:43], s35 offen offset:0 nt
    buffer_load_dwordx4 v[68:71], v2, s[40:43], s35 offen offset:128 nt
    buffer_load_dwordx4 v[72:75], v2, s[40:43], s35 offen offset:256 nt
    s_add_u32 s35, s71, 1
    s_and_b32 s35, s35, 7
    s_mul_i32 s35, s35, 3072
    buffer_load_dwordx4 v[76:79], v2, s[40:43], s35 offen offset:0 nt
    buffer_load_dwordx4 v[80:83], v2, s[40:43], s35 offen offset:128 nt
    buffer_load_dwordx4 v[84:87], v2, s[40:43], s35 offen offset:256 nt
    s_add_u32 s35, s71, 2
    s_and_b32 s35, s35, 7
    s_mul_i32 s35, s35, 3072
    buffer_load_dwordx4 v[88:91], v2, s[40:43], s35 offen offset:0 nt
    buffer_load_dwordx4 v[92:95], v2, s[40:43], s35 offen offset:128 nt
    buffer_load_dwordx4 v[96:99], v2, s[40:43], s35 offen offset:256 nt
    s_add_u32 s35, s71, 3
    s_and_b32 s35, s35, 7
    s_mul_i32 s35, s35, 3072
    buffer_load_dwordx4 v[100:103], v2, s[40:43], s35 offen offset:0 nt
    buffer_load_dwordx4 v[104:107], v2, s[40:43], s35 offen offset:128 nt
    buffer_load_dwordx4 v[108:111], v2, s[40:43], s35 offen offset:256 nt
    s_add_u32 s35, s71, 4
    s_and_b32 s35, s35, 7
    s_mul_i32 s35, s35, 3072
    buffer_load_dwordx4 v[112:115], v2, s[40:43], s35 offen offset:0 nt
    buffer_load_dwordx4 v[116:119], v2, s[40:43], s35 offen offset:128 nt
    buffer_load_dwordx4 v[120:123], v2, s[40:43], s35 offen offset:256 nt
    s_add_u32 s35, s71, 5
    s_and_b32 s35, s35, 7
    s_mul_i32 s35, s35, 3072
    buffer_load_dwordx4 v[124:127], v2, s[40:43], s35 offen offset:0 nt
    buffer_load_dwordx4 v[128:131], v2, s[40:43], s35 offen offset:128 nt
    buffer_load_dwordx4 v[132:135], v2, s[40:43], s35 offen offset:256 nt
    s_add_u32 s35, s71, 6
    s_and_b32 s35, s35, 7
    s_mul_i32 s35, s35, 3072
    buffer_load_dwordx4 v[136:139], v2, s[40:43], s35 offen offset:0 nt
    buffer_load_dwordx4 v[140:143], v2, s[40:43], s35 offen offset:128 nt
    buffer_load_dwordx4 v[144:147], v2, s[40:43], s35 offen offset:256 nt
    s_add_u32 s35, s71, 7
    s_and_b32 s35, s35, 7
    s_mul_i32 s35, s35, 3072
    buffer_load_dwordx4 v[148:151], v2, s[40:43], s35 offen offset:0 nt
    buffer_load_dwordx4 v[152:155], v2, s[40:43], s35 offen offset:128 nt
    buffer_load_dwordx4 v[156:159], v2, s[40:43], s35 offen offset:256 nt
    s_add_u32 s35, s71, 0
    s_and_b32 s35, s35, 7
    s_mul_i32 s35, s35, 3072
    buffer_load_dwordx4 v[160:163], v2, s[44:47], s35 offen offset:0 nt
    buffer_load_dwordx4 v[164:167], v2, s[44:47], s35 offen offset:128 nt
    buffer_load_dwordx4 v[168:171], v2, s[44:47], s35 offen offset:256 nt
    s_add_u32 s35, s71, 1
    s_and_b32 s35, s35, 7
    s_mul_i32 s35, s35, 3072
    buffer_load_dwordx4 v[172:175], v2, s[44:47], s35 offen offset:0 nt
    buffer_load_dwordx4 v[176:179], v2, s[44:47], s35 offen offset:128 nt
    buffer_load_dwordx4 v[180:183], v2, s[44:47], s35 offen offset:256 nt
    s_add_u32 s35, s71, 2
    s_and_b32 s35, s35, 7
    s_mul_i32 s35, s35, 3072
    buffer_load_dwordx4 v[184:187], v2, s[44:47], s35 offen offset:0 nt
    buffer_load_dwordx4 v[188:191], v2, s[44:47], s35 offen offset:128 nt
    buffer_load_dwordx4 v[192:195], v2, s[44:47], s35 offen offset:256 nt
    s_add_u32 s35, s71, 3
    s_and_b32 s35, s35, 7
    s_mul_i32 s35, s35, 3072
    buffer_load_dwordx4 v[196:199], v2, s[44:47], s35 offen offset:0 nt
    buffer_load_dwordx4 v[200:203], v2, s[44:47], s35 offen offset:128 nt
    buffer_load_dwordx4 v[204:207], v2, s[44:47], s35 offen offset:256 nt
    s_waitcnt lgkmcnt(0)
    s_add_u32 s93, s93, 1
    s_and_b32 s94, s93, 0xff
    s_and_b32 s95, s93, 0xffff
    s_branch L_KV_BQ
L_KV_LOOP:
    s_barrier
L_KV_BQ:
    s_barrier
    s_setprio 3
    s_cmp_eq_u32 s31, 0
    s_cbranch_scc0 L_kvv_1
    v_mov_b32 v52, 22208
    ds_read_b32 v53, v52
    s_waitcnt lgkmcnt(0)
    v_readfirstlane_b32 s79, v53
    s_nop 0
    s_and_b32 s79, s79, 1
L_kvv_1:
    ds_read_b128 v[12:15], v6 offset:21760
    ds_read_b128 v[16:19], v6 offset:21888
    ds_read_b128 v[20:23], v6 offset:22016
    s_waitcnt vmcnt(12)
    s_waitcnt lgkmcnt(2)
    v_dot2_f32_bf16 v24, v64, v12, 0
    v_dot2_f32_bf16 v25, v76, v12, 0
    v_dot2_f32_bf16 v26, v88, v12, 0
    v_dot2_f32_bf16 v27, v100, v12, 0
    v_dot2_f32_bf16 v28, v112, v12, 0
    v_dot2_f32_bf16 v29, v124, v12, 0
    v_dot2_f32_bf16 v30, v136, v12, 0
    v_dot2_f32_bf16 v31, v148, v12, 0
    v_dot2c_f32_bf16 v24, v65, v13
    v_dot2c_f32_bf16 v25, v77, v13
    v_dot2c_f32_bf16 v26, v89, v13
    v_dot2c_f32_bf16 v27, v101, v13
    v_dot2c_f32_bf16 v28, v113, v13
    v_dot2c_f32_bf16 v29, v125, v13
    v_dot2c_f32_bf16 v30, v137, v13
    v_dot2c_f32_bf16 v31, v149, v13
    v_dot2c_f32_bf16 v24, v66, v14
    v_dot2c_f32_bf16 v25, v78, v14
    v_dot2c_f32_bf16 v26, v90, v14
    v_dot2c_f32_bf16 v27, v102, v14
    v_dot2c_f32_bf16 v28, v114, v14
    v_dot2c_f32_bf16 v29, v126, v14
    v_dot2c_f32_bf16 v30, v138, v14
    v_dot2c_f32_bf16 v31, v150, v14
    v_dot2c_f32_bf16 v24, v67, v15
    v_dot2c_f32_bf16 v25, v79, v15
    v_dot2c_f32_bf16 v26, v91, v15
    v_dot2c_f32_bf16 v27, v103, v15
    v_dot2c_f32_bf16 v28, v115, v15
    v_dot2c_f32_bf16 v29, v127, v15
    v_dot2c_f32_bf16 v30, v139, v15
    v_dot2c_f32_bf16 v31, v151, v15
    s_waitcnt lgkmcnt(1)
    v_dot2c_f32_bf16 v24, v68, v16
    v_dot2c_f32_bf16 v25, v80, v16
    v_dot2c_f32_bf16 v26, v92, v16
    v_dot2c_f32_bf16 v27, v104, v16
    v_dot2c_f32_bf16 v28, v116, v16
    v_dot2c_f32_bf16 v29, v128, v16
    v_dot2c_f32_bf16 v30, v140, v16
    v_dot2c_f32_bf16 v31, v152, v16
    v_dot2c_f32_bf16 v24, v69, v17
    v_dot2c_f32_bf16 v25, v81, v17
    v_dot2c_f32_bf16 v26, v93, v17
    v_dot2c_f32_bf16 v27, v105, v17
    v_dot2c_f32_bf16 v28, v117, v17
    v_dot2c_f32_bf16 v29, v129, v17
    v_dot2c_f32_bf16 v30, v141, v17
    v_dot2c_f32_bf16 v31, v153, v17
    v_dot2c_f32_bf16 v24, v70, v18
    v_dot2c_f32_bf16 v25, v82, v18
    v_dot2c_f32_bf16 v26, v94, v18
    v_dot2c_f32_bf16 v27, v106, v18
    v_dot2c_f32_bf16 v28, v118, v18
    v_dot2c_f32_bf16 v29, v130, v18
    v_dot2c_f32_bf16 v30, v142, v18
    v_dot2c_f32_bf16 v31, v154, v18
    v_dot2c_f32_bf16 v24, v71, v19
    v_dot2c_f32_bf16 v25, v83, v19
    v_dot2c_f32_bf16 v26, v95, v19
    v_dot2c_f32_bf16 v27, v107, v19
    v_dot2c_f32_bf16 v28, v119, v19
    v_dot2c_f32_bf16 v29, v131, v19
    v_dot2c_f32_bf16 v30, v143, v19
    v_dot2c_f32_bf16 v31, v155, v19
    s_waitcnt lgkmcnt(0)
    v_dot2c_f32_bf16 v24, v72, v20
    v_dot2c_f32_bf16 v25, v84, v20
    v_dot2c_f32_bf16 v26, v96, v20
    v_dot2c_f32_bf16 v27, v108, v20
    v_dot2c_f32_bf16 v28, v120, v20
    v_dot2c_f32_bf16 v29, v132, v20
    v_dot2c_f32_bf16 v30, v144, v20
    v_dot2c_f32_bf16 v31, v156, v20
    v_dot2c_f32_bf16 v24, v73, v21
    v_dot2c_f32_bf16 v25, v85, v21
    v_dot2c_f32_bf16 v26, v97, v21
    v_dot2c_f32_bf16 v27, v109, v21
    v_dot2c_f32_bf16 v28, v121, v21
    v_dot2c_f32_bf16 v29, v133, v21
    v_dot2c_f32_bf16 v30, v145, v21
    v_dot2c_f32_bf16 v31, v157, v21
    v_dot2c_f32_bf16 v24, v74, v22
    v_dot2c_f32_bf16 v25, v86, v22
    v_dot2c_f32_bf16 v26, v98, v22
    v_dot2c_f32_bf16 v27, v110, v22
    v_dot2c_f32_bf16 v28, v122, v22
    v_dot2c_f32_bf16 v29, v134, v22
    v_dot2c_f32_bf16 v30, v146, v22
    v_dot2c_f32_bf16 v31, v158, v22
    v_dot2c_f32_bf16 v24, v75, v23
    v_dot2c_f32_bf16 v25, v87, v23
    v_dot2c_f32_bf16 v26, v99, v23
    v_dot2c_f32_bf16 v27, v111, v23
    v_dot2c_f32_bf16 v28, v123, v23
    v_dot2c_f32_bf16 v29, v135, v23
    v_dot2c_f32_bf16 v30, v147, v23
    v_dot2c_f32_bf16 v31, v159, v23
    v_add_f32_dpp v24, v24, v24 row_shl:4 row_mask:0xf bank_mask:0x5
    v_add_f32_dpp v25, v25, v25 row_shl:4 row_mask:0xf bank_mask:0x5
    v_add_f32_dpp v26, v26, v26 row_shl:4 row_mask:0xf bank_mask:0x5
    v_add_f32_dpp v27, v27, v27 row_shl:4 row_mask:0xf bank_mask:0x5
    v_add_f32_dpp v24, v28, v28 row_shr:4 row_mask:0xf bank_mask:0xa
    v_add_f32_dpp v25, v29, v29 row_shr:4 row_mask:0xf bank_mask:0xa
    v_add_f32_dpp v26, v30, v30 row_shr:4 row_mask:0xf bank_mask:0xa
    v_add_f32_dpp v27, v31, v31 row_shr:4 row_mask:0xf bank_mask:0xa
    v_add_f32_dpp v24, v24, v24 quad_perm:[1,0,3,2] row_mask:0xf bank_mask:0xf
    v_add_f32_dpp v25, v25, v25 quad_perm:[1,0,3,2] row_mask:0xf bank_mask:0xf
    v_add_f32_dpp v26, v26, v26 quad_perm:[1,0,3,2] row_mask:0xf bank_mask:0xf
    v_add_f32_dpp v27, v27, v27 quad_perm:[1,0,3,2] row_mask:0xf bank_mask:0xf
    v_add_f32_dpp v24, v24, v24 quad_perm:[2,3,0,1] row_mask:0xf bank_mask:0xf
    v_add_f32_dpp v25, v25, v25 quad_perm:[2,3,0,1] row_mask:0xf bank_mask:0xf
    v_add_f32_dpp v26, v26, v26 quad_perm:[2,3,0,1] row_mask:0xf bank_mask:0xf
    v_add_f32_dpp v27, v27, v27 quad_perm:[2,3,0,1] row_mask:0xf bank_mask:0xf
    v_max3_f32 v32, v24, v25, v26
    v_max_f32 v32, v32, v27
    s_nop 1
    v_max_f32_dpp v32, v32, v32 row_ror:4 row_mask:0xf bank_mask:0xf
    s_nop 1
    v_max_f32_dpp v32, v32, v32 row_ror:8 row_mask:0xf bank_mask:0xf
    v_mov_b32 v33, v32
    s_nop 1
    v_permlane16_swap_b32 v32, v33
    v_max_f32 v32, v32, v33
    v_mov_b32 v33, v32
    s_nop 1
    v_permlane32_swap_b32 v32, v33
    v_max_f32 v32, v32, v33
    v_mul_f32 v12, s70, v32
    s_lshl_b32 s32, s78, 3
    s_lshl_b32 s33, s31, 5
    s_add_u32 s32, s32, s33
    v_mov_b32 v14, s32
    v_mov_b32 v13, 1
    s_mov_b32 exec_lo, 0x1
    s_mov_b32 exec_hi, 0x0
    ds_write_b64 v14, v[12:13] offset:22144
    s_mov_b64 exec, -1
    v_fma_f32 v24, v24, s70, -v12
    v_fma_f32 v25, v25, s70, -v12
    v_fma_f32 v26, v26, s70, -v12
    v_fma_f32 v27, v27, s70, -v12
    v_exp_f32 v24, v24
    v_exp_f32 v25, v25
    v_exp_f32 v26, v26
    v_exp_f32 v27, v27
    v_cvt_pk_bf16_f32 v52, v24, v24
    v_cvt_pk_bf16_f32 v53, v25, v25
    v_cvt_pk_bf16_f32 v54, v26, v26
    v_cvt_pk_bf16_f32 v55, v27, v27
    s_cmp_eq_u32 s31, 0
    s_cbranch_scc0 L_vl_2
    s_add_u32 s35, s71, 4
    s_and_b32 s35, s35, 7
    s_mul_i32 s35, s35, 3072
    buffer_load_dwordx4 v[208:211], v2, s[44:47], s35 offen offset:0 nt
    buffer_load_dwordx4 v[212:215], v2, s[44:47], s35 offen offset:128 nt
    buffer_load_dwordx4 v[216:219], v2, s[44:47], s35 offen offset:256 nt
    s_add_u32 s35, s71, 5
    s_and_b32 s35, s35, 7
    s_mul_i32 s35, s35, 3072
    buffer_load_dwordx4 v[220:223], v2, s[44:47], s35 offen offset:0 nt
    buffer_load_dwordx4 v[224:227], v2, s[44:47], s35 offen offset:128 nt
    buffer_load_dwordx4 v[228:231], v2, s[44:47], s35 offen offset:256 nt
    s_add_u32 s35, s71, 6
    s_and_b32 s35, s35, 7
    s_mul_i32 s35, s35, 3072
    buffer_load_dwordx4 v[232:235], v2, s[44:47], s35 offen offset:0 nt
    buffer_load_dwordx4 v[236:239], v2, s[44:47], s35 offen offset:128 nt
    buffer_load_dwordx4 v[240:243], v2, s[44:47], s35 offen offset:256 nt
    s_add_u32 s35, s71, 7
    s_and_b32 s35, s35, 7
    s_mul_i32 s35, s35, 3072
    buffer_load_dwordx4 v[244:247], v2, s[44:47], s35 offen offset:0 nt
    buffer_load_dwordx4 v[248:251], v2, s[44:47], s35 offen offset:128 nt
    buffer_load_dwordx4 v[252:255], v2, s[44:47], s35 offen offset:256 nt
    s_barrier
L_vl_2:
    v_and_b32 v32, v52, v8
    v_and_b32 v33, v52, v9
    v_and_b32_dpp v34, v52, v10 row_shr:4 row_mask:0xf bank_mask:0xf bound_ctrl:1
    v_and_b32_dpp v35, v52, v11 row_shr:4 row_mask:0xf bank_mask:0xf bound_ctrl:1
    v_and_b32 v36, v53, v8
    v_and_b32 v37, v53, v9
    v_and_b32_dpp v38, v53, v10 row_shr:4 row_mask:0xf bank_mask:0xf bound_ctrl:1
    v_and_b32_dpp v39, v53, v11 row_shr:4 row_mask:0xf bank_mask:0xf bound_ctrl:1
    s_waitcnt vmcnt(21)
    v_mfma_f32_16x16x32_bf16 v[40:43], v[32:35], v[160:163], 0
    v_mfma_f32_16x16x32_bf16 v[44:47], v[32:35], v[164:167], 0
    v_mfma_f32_16x16x32_bf16 v[48:51], v[32:35], v[168:171], 0
    v_add_f32 v24, v24, v25
    v_add_f32 v26, v26, v27
    v_add_f32 v15, v24, v26
    v_and_b32 v32, v54, v8
    v_and_b32 v33, v54, v9
    v_and_b32_dpp v34, v54, v10 row_shr:4 row_mask:0xf bank_mask:0xf bound_ctrl:1
    v_and_b32_dpp v35, v54, v11 row_shr:4 row_mask:0xf bank_mask:0xf bound_ctrl:1
    s_waitcnt vmcnt(18)
    v_mfma_f32_16x16x32_bf16 v[40:43], v[36:39], v[172:175], v[40:43]
    v_mfma_f32_16x16x32_bf16 v[44:47], v[36:39], v[176:179], v[44:47]
    v_mfma_f32_16x16x32_bf16 v[48:51], v[36:39], v[180:183], v[48:51]
    v_add_f32_dpp v15, v15, v15 row_ror:4 row_mask:0xf bank_mask:0xf
    s_nop 1
    v_add_f32_dpp v15, v15, v15 row_ror:8 row_mask:0xf bank_mask:0xf
    v_mov_b32 v14, v15
    s_nop 1
    v_permlane16_swap_b32 v15, v14
    v_add_f32 v15, v15, v14
    v_mov_b32 v14, v15
    s_nop 1
    v_permlane32_swap_b32 v15, v14
    v_add_f32 v15, v15, v14
    v_and_b32 v36, v55, v8
    v_and_b32 v37, v55, v9
    v_and_b32_dpp v38, v55, v10 row_shr:4 row_mask:0xf bank_mask:0xf bound_ctrl:1
    v_and_b32_dpp v39, v55, v11 row_shr:4 row_mask:0xf bank_mask:0xf bound_ctrl:1
    s_waitcnt vmcnt(15)
    v_mfma_f32_16x16x32_bf16 v[40:43], v[32:35], v[184:187], v[40:43]
    v_mfma_f32_16x16x32_bf16 v[44:47], v[32:35], v[188:191], v[44:47]
    v_mfma_f32_16x16x32_bf16 v[48:51], v[32:35], v[192:195], v[48:51]
    s_lshl_b32 s33, s31, 5
    v_mov_b32 v14, s33
    ds_read_b128 v[16:19], v14 offset:22144
    ds_read_b128 v[20:23], v14 offset:22160
    v_and_b32_dpp v32, v52, v8 row_shl:4 row_mask:0xf bank_mask:0xf bound_ctrl:1
    v_and_b32_dpp v33, v52, v9 row_shl:4 row_mask:0xf bank_mask:0xf bound_ctrl:1
    v_and_b32 v34, v52, v10
    v_and_b32 v35, v52, v11
    s_waitcnt vmcnt(12)
    v_mfma_f32_16x16x32_bf16 v[40:43], v[36:39], v[196:199], v[40:43]
    v_mfma_f32_16x16x32_bf16 v[44:47], v[36:39], v[200:203], v[44:47]
    v_mfma_f32_16x16x32_bf16 v[48:51], v[36:39], v[204:207], v[48:51]
    v_and_b32_dpp v36, v53, v8 row_shl:4 row_mask:0xf bank_mask:0xf bound_ctrl:1
    v_and_b32_dpp v37, v53, v9 row_shl:4 row_mask:0xf bank_mask:0xf bound_ctrl:1
    v_and_b32 v38, v53, v10
    v_and_b32 v39, v53, v11
    s_waitcnt vmcnt(9)
    v_mfma_f32_16x16x32_bf16 v[40:43], v[32:35], v[208:211], v[40:43]
    v_mfma_f32_16x16x32_bf16 v[44:47], v[32:35], v[212:215], v[44:47]
    v_mfma_f32_16x16x32_bf16 v[48:51], v[32:35], v[216:219], v[48:51]
    s_mov_b32 s34, 0x100000
L_mx_3:
    s_waitcnt lgkmcnt(0)
    v_min3_u32 v17, v17, v19, v21
    v_min_u32 v17, v17, v23
    v_cmp_eq_u32 vcc, 0, v17
    s_cbranch_vccz L_mxd_4
    ds_read_b128 v[16:19], v14 offset:22144
    ds_read_b128 v[20:23], v14 offset:22160
    s_sub_u32 s34, s34, 1
    s_cbranch_scc0 L_mx_3
L_mxd_4:
    v_max3_f32 v16, v16, v18, v20
    v_max_f32 v16, v16, v22
    v_sub_f32 v17, v12, v16
    v_exp_f32 v17, v17
    v_mul_f32 v18, 0.25, v16
    v_mul_f32 v19, v15, v17
    v_and_b32_dpp v32, v54, v8 row_shl:4 row_mask:0xf bank_mask:0xf bound_ctrl:1
    v_and_b32_dpp v33, v54, v9 row_shl:4 row_mask:0xf bank_mask:0xf bound_ctrl:1
    v_and_b32 v34, v54, v10
    v_and_b32 v35, v54, v11
    s_waitcnt vmcnt(6)
    v_mfma_f32_16x16x32_bf16 v[40:43], v[36:39], v[220:223], v[40:43]
    v_mfma_f32_16x16x32_bf16 v[44:47], v[36:39], v[224:227], v[44:47]
    v_mfma_f32_16x16x32_bf16 v[48:51], v[36:39], v[228:231], v[48:51]
    s_mov_b32 exec_lo, 0xf
    s_mov_b32 exec_hi, 0x0
    ds_write_b64 v3, v[18:19] offset:5120
    s_mov_b64 exec, -1
    v_and_b32_dpp v36, v55, v8 row_shl:4 row_mask:0xf bank_mask:0xf bound_ctrl:1
    v_and_b32_dpp v37, v55, v9 row_shl:4 row_mask:0xf bank_mask:0xf bound_ctrl:1
    v_and_b32 v38, v55, v10
    v_and_b32 v39, v55, v11
    s_waitcnt vmcnt(3)
    v_mfma_f32_16x16x32_bf16 v[40:43], v[32:35], v[232:235], v[40:43]
    v_mfma_f32_16x16x32_bf16 v[44:47], v[32:35], v[236:239], v[44:47]
    v_mfma_f32_16x16x32_bf16 v[48:51], v[32:35], v[240:243], v[48:51]
    s_waitcnt vmcnt(0)
    v_mfma_f32_16x16x32_bf16 v[40:43], v[36:39], v[244:247], v[40:43]
    v_mfma_f32_16x16x32_bf16 v[44:47], v[36:39], v[248:251], v[44:47]
    v_mfma_f32_16x16x32_bf16 v[48:51], v[36:39], v[252:255], v[48:51]
    s_nop 5
    v_permlane32_swap_b32 v40, v41
    v_permlane32_swap_b32 v42, v43
    v_permlane32_swap_b32 v44, v45
    v_permlane32_swap_b32 v46, v47
    v_permlane32_swap_b32 v48, v49
    v_permlane32_swap_b32 v50, v51
    v_add_f32_dpp v40, v41, v40 row_ror:8 row_mask:0xf bank_mask:0xf
    v_add_f32_dpp v42, v43, v42 row_ror:8 row_mask:0xf bank_mask:0xf
    v_add_f32_dpp v44, v45, v44 row_ror:8 row_mask:0xf bank_mask:0xf
    v_add_f32_dpp v46, v47, v46 row_ror:8 row_mask:0xf bank_mask:0xf
    v_add_f32_dpp v48, v49, v48 row_ror:8 row_mask:0xf bank_mask:0xf
    v_add_f32_dpp v50, v51, v50 row_ror:8 row_mask:0xf bank_mask:0xf
    v_mov_b32_dpp v40, v42 row_ror:8 row_mask:0xf bank_mask:0xc
    v_mov_b32_dpp v44, v46 row_ror:8 row_mask:0xf bank_mask:0xc
    v_mov_b32_dpp v48, v50 row_ror:8 row_mask:0xf bank_mask:0xc
    v_mul_f32 v40, v40, v17
    v_mul_f32 v44, v44, v17
    v_mul_f32 v48, v48, v17
    ds_write_b32 v7, v40 offset:4352
    ds_write_b32 v7, v44 offset:4608
    ds_write_b32 v7, v48 offset:4864
    s_waitcnt lgkmcnt(0)
    s_barrier
    s_cmp_eq_u32 s30, 0
    s_cbranch_scc0 L_kvo_5
    s_mov_b32 exec_lo, 0xffffffff
    s_mov_b32 exec_hi, 0xfffff
    ds_read_b128 v[24:27], v5 offset:4352
    ds_read_b128 v[28:31], v5 offset:5376
    ds_read_b128 v[32:35], v5 offset:6400
    ds_read_b128 v[36:39], v5 offset:7424
    s_waitcnt lgkmcnt(0)
    v_pk_add_f32 v[24:25], v[24:25], v[28:29]
    v_pk_add_f32 v[32:33], v[32:33], v[36:37]
    v_pk_add_f32 v[26:27], v[26:27], v[30:31]
    v_pk_add_f32 v[34:35], v[34:35], v[38:39]
    v_pk_add_f32 v[24:25], v[24:25], v[32:33]
    v_pk_add_f32 v[26:27], v[26:27], v[34:35]
    v_bfi_b32 v24, v62, s93, v24
    s_cmp_eq_u32 s79, 1
    s_cbranch_scc0 L_sts_6
    buffer_store_dwordx4 v[24:27], v5, s[36:39], s84 offen
L_stb_7:
    s_mov_b64 exec, -1
L_kvo_5:
    s_cmp_eq_u32 s31, 0
    s_cbranch_scc0 L_kvo2_8
    s_barrier
L_kvo2_8:
    s_barrier
    s_cmp_eq_u32 s30, 0
    s_cbranch_scc0 L_kvw_9
    s_cmp_ge_u32 s29, 12
    s_cbranch_scc0 L_kvw_9
    ds_read_b128 v[24:27], v5 offset:8704
    ds_read_b128 v[28:31], v5 offset:9728
    ds_read_b128 v[32:35], v5 offset:10752
    ds_read_b128 v[36:39], v5 offset:11776
    s_mov_b32 exec_lo, 0xffffffff
    s_mov_b32 exec_hi, 0x0
    s_waitcnt lgkmcnt(0)
    v_pk_add_f32 v[24:25], v[24:25], v[28:29]
    v_pk_add_f32 v[32:33], v[32:33], v[36:37]
    v_pk_add_f32 v[26:27], v[26:27], v[30:31]
    v_pk_add_f32 v[34:35], v[34:35], v[38:39]
    v_pk_add_f32 v[24:25], v[24:25], v[32:33]
    v_pk_add_f32 v[26:27], v[26:27], v[34:35]
    v_bfi_b32 v24, v62, s93, v24
    buffer_store_dwordx4 v[24:27], v4, s[36:39], s85 offen sc1
    s_mov_b32 exec_lo, 0x1
    s_mov_b32 exec_hi, 0x0
    v_mov_b32 v28, s93
    s_cmp_eq_u32 s79, 1
    s_cbranch_scc0 L_sts_10
    buffer_store_dword v28, off, s[36:39], s89
L_stb_11:
    s_mov_b64 exec, -1
L_kvw_9:
    s_barrier
    s_cmp_eq_u32 s30, 0
    s_cbranch_scc0 L_kvg_12
    s_cmp_lt_u32 s29, 15
    s_cbranch_scc0 L_kvg_12
    ds_read_b128 v[24:27], v5 offset:13056
    ds_read_b128 v[28:31], v5 offset:14080
    ds_read_b128 v[32:35], v5 offset:15104
    ds_read_b128 v[36:39], v5 offset:16128
    v_mov_b32 v48, 0
    ds_read_b128 v[40:43], v48 offset:17152
    ds_read_b128 v[44:47], v48 offset:17168
    v_mov_b32 v49, v4
    s_cmp_eq_u32 s31, 0
    s_cbranch_scc0 L_pub1_13
    s_mov_b32 exec_lo, 0x0
    s_mov_b32 exec_hi, 0xffffffff
    v_add_u32 v49, 122880, v49
    s_mov_b64 exec, -1
    s_branch L_pub2_14
L_pub1_13:
    s_mov_b32 exec_lo, 0xffffffff
    s_mov_b32 exec_hi, 0x0
L_pub2_14:
    s_waitcnt lgkmcnt(2)
    v_pk_add_f32 v[24:25], v[24:25], v[28:29]
    v_pk_add_f32 v[32:33], v[32:33], v[36:37]
    v_pk_add_f32 v[26:27], v[26:27], v[30:31]
    v_pk_add_f32 v[34:35], v[34:35], v[38:39]
    v_pk_add_f32 v[24:25], v[24:25], v[32:33]
    v_pk_add_f32 v[26:27], v[26:27], v[34:35]
    v_bfi_b32 v24, v62, s93, v24
    s_cmp_eq_u32 s79, 1
    s_cbranch_scc0 L_sts_15
    buffer_store_dwordx4 v[24:27], v49, s[36:39], s86 offen
L_stb_16:
    s_waitcnt lgkmcnt(0)
    s_mov_b32 exec_lo, 0x1
    s_mov_b32 exec_hi, 0x0
    v_pk_add_f32 v[40:41], v[40:41], v[42:43]
    v_pk_add_f32 v[44:45], v[44:45], v[46:47]
    v_add_f32 v40, v40, v41
    v_add_f32 v41, v44, v45
    v_mov_b32 v42, s93
    v_mov_b32 v43, s93
    s_cmp_eq_u32 s79, 1
    s_cbranch_scc0 L_sts_18
    buffer_store_dwordx4 v[40:43], off, s[36:39], s87
L_stb_19:
L_nost_17:
    s_mov_b64 exec, -1
L_kvg_12:
    s_barrier
    s_cmp_eq_u32 s30, 0
    s_cbranch_scc0 L_kvd_20
    s_cmp_lt_u32 s29, 15
    s_cbranch_scc0 L_kvd_20
    ds_read_b128 v[24:27], v5 offset:17408
    ds_read_b128 v[28:31], v5 offset:18432
    ds_read_b128 v[32:35], v5 offset:19456
    ds_read_b128 v[36:39], v5 offset:20480
    s_mov_b32 exec_lo, 0xffffffff
    s_mov_b32 exec_hi, 0x0
    s_waitcnt lgkmcnt(0)
    v_pk_add_f32 v[24:25], v[24:25], v[28:29]
    v_pk_add_f32 v[32:33], v[32:33], v[36:37]
    v_pk_add_f32 v[26:27], v[26:27], v[30:31]
    v_pk_add_f32 v[34:35], v[34:35], v[38:39]
    v_pk_add_f32 v[24:25], v[24:25], v[32:33]
    v_pk_add_f32 v[26:27], v[26:27], v[34:35]
    v_bfi_b32 v24, v62, s93, v24
    buffer_store_dwordx4 v[24:27], v4, s[36:39], s88 offen sc1
    s_mov_b32 exec_lo, 0x1
    s_mov_b32 exec_hi, 0x0
    v_mov_b32 v28, s93
    s_cmp_eq_u32 s79, 1
    s_cbranch_scc0 L_sts_21
    buffer_store_dword v28, off, s[36:39], s90
L_stb_22:
    s_mov_b64 exec, -1
L_kvd_20:
    s_add_u32 s31, s31, 1
    s_add_u32 s84, s84, 262144
    s_add_u32 s85, s85, 81920
    s_add_u32 s86, s86, 61440
    s_add_u32 s87, s87, 3072
    s_add_u32 s88, s88, 61440
    s_add_u32 s89, s89, 1024
    s_add_u32 s90, s90, 1024
    s_cmp_lt_u32 s31, 2
    s_cbranch_scc1 L_KV_LOOP
    s_endpgm
L_sts_6:
    buffer_store_dwordx4 v[24:27], v5, s[36:39], s84 offen sc1
    s_branch L_stb_7
L_sts_10:
    buffer_store_dword v28, off, s[36:39], s89 sc1
    s_branch L_stb_11
L_sts_15:
    buffer_store_dwordx4 v[24:27], v49, s[36:39], s86 offen sc1
    s_branch L_stb_16
L_sts_18:
    buffer_store_dwordx4 v[40:43], off, s[36:39], s87 sc1
    s_branch L_stb_19
L_sts_21:
    buffer_store_dword v28, off, s[36:39], s90 sc1
    s_branch L_stb_22
L_W:
    s_setprio 2
    v_and_b32 v52, 7, v1
    v_lshrrev_b32 v53, 3, v1
    v_lshrrev_b32 v54, 4, v1
    v_and_b32 v55, 15, v1
    v_lshlrev_b32 v18, 4, v1
    v_mov_b32 v7, 0
    s_cmp_eq_u32 s78, 0
    s_cbranch_scc0 L_lz_23
    v_mov_b32 v192, 0
    v_mov_b32 v193, 0
    v_mov_b32 v194, 0
    v_mov_b32 v195, 0
    s_mov_b32 exec_lo, 0x3f
    s_mov_b32 exec_hi, 0x0
    ds_write_b128 v18, v[192:195] offset:22144
    s_mov_b64 exec, -1
L_lz_23:
    s_lshl_b32 s32, s72, 7
    s_lshl_b32 s33, s78, 5
    s_add_u32 s81, s32, s33
    s_mul_i32 s32, s81, 12288
    s_mul_i32 s33, s28, 1536
    s_add_u32 s32, s32, s33
    s_lshl_b32 s33, s73, 8
    s_add_u32 s32, s32, s33
    s_cmp_ge_u32 s29, 2
    s_cbranch_scc0 L_noq0_24
    s_add_u32 s40, s10, s32
    s_addc_u32 s41, s11, 0
    s_and_b32 s41, s41, 0xffff
    s_sub_u32 s42, 0x780000, s32
    s_mov_b32 s43, 0x20000
    s_mov_b32 s60, s4
    s_and_b32 s61, s5, 0xffff
    s_mov_b32 s62, 0x500
    s_mov_b32 s63, 0x20000
    v_mul_u32_u24 v2, 12288, v54
    v_lshl_add_u32 v2, v55, 4, v2
    v_lshl_add_u32 v56, v52, 2, v54
    v_add_u32 v56, s81, v56
    v_lshlrev_b32 v56, 1, v56
    buffer_load_ushort v25, v56, s[60:63], 0 offen
    v_lshlrev_b32 v56, 2, v1
    buffer_load_dwordx4 v[224:227], v18, s[60:63], 0 offen
    buffer_load_dword v228, v56, s[60:63], 0 offen offset:1024
    buffer_load_dwordx4 v[64:67], v2, s[40:43], 0 offen nt
    s_mov_b32 s35, 49152
    buffer_load_dwordx4 v[68:71], v2, s[40:43], s35 offen nt
    s_mov_b32 s35, 98304
    buffer_load_dwordx4 v[72:75], v2, s[40:43], s35 offen nt
    s_mov_b32 s35, 147456
    buffer_load_dwordx4 v[76:79], v2, s[40:43], s35 offen nt
    s_mov_b32 s35, 196608
    buffer_load_dwordx4 v[80:83], v2, s[40:43], s35 offen nt
    s_mov_b32 s35, 245760
    buffer_load_dwordx4 v[84:87], v2, s[40:43], s35 offen nt
    s_mov_b32 s35, 294912
    buffer_load_dwordx4 v[88:91], v2, s[40:43], s35 offen nt
    s_mov_b32 s35, 344064
    buffer_load_dwordx4 v[92:95], v2, s[40:43], s35 offen nt
L_noq0_24:
    v_lshlrev_b32 v17, 5, v55
    v_and_b32 v57, 1, v54
    v_lshl_add_u32 v17, v57, 4, v17
    s_lshl_b32 s32, s28, 7
    s_add_u32 s88, s32, 1383680
    s_add_u32 s89, s32, 1384704
    s_lshl_b32 s33, s72, 4
    s_add_u32 s91, s32, s33
    s_add_u32 s91, s91, 368896
    s_mul_i32 s32, s28, 5
    s_add_u32 s32, s32, s72
    s_mul_i32 s32, s32, 3072
    s_lshl_b32 s33, s73, 9
    s_add_u32 s90, s32, s33
    s_add_u32 s90, s90, 256
    s_cmp_eq_u32 s78, 2
    s_cbranch_scc0 L_ptw_25
    s_add_u32 s32, s90, 0
    buffer_load_dwordx4 v[248:251], v17, s[36:39], s32 offen sc1
    s_add_u32 s32, s90, 122880
    buffer_load_dwordx4 v[248:251], v17, s[36:39], s32 offen sc1
    s_add_u32 s32, s90, 245760
    buffer_load_dwordx4 v[248:251], v17, s[36:39], s32 offen sc1
    buffer_load_dword v248, off, s[36:39], s91 offset:0 sc1
    buffer_load_dword v248, off, s[36:39], s91 offset:1024 sc1
    s_lshl_b32 s32, s28, 5
    s_add_u32 s32, s32, s29
    s_lshl_b32 s32, s32, 10
    s_add_u32 s33, s32, 377088
    buffer_load_dwordx4 v[248:251], v18, s[36:39], s33 offen sc1
    s_add_u32 s33, s32, 639232
    buffer_load_dwordx4 v[248:251], v18, s[36:39], s33 offen sc1
    buffer_load_dword v248, off, s[36:39], s88 offset:0 sc1
    buffer_load_dword v248, off, s[36:39], s88 offset:1024 sc1
    buffer_load_dword v248, off, s[36:39], s89 offset:1024 sc1
    buffer_load_dword v248, off, s[36:39], s89 offset:2048 sc1
    s_mul_i32 s32, s28, 3
    s_add_u32 s32, s32, s76
    s_lshl_b32 s35, s32, 7
    s_add_u32 s35, s35, 1249536
    s_mul_i32 s32, s32, 5
    s_add_u32 s32, s32, s77
    s_lshl_b32 s32, s32, 9
    s_add_u32 s33, s32, 1065216
    buffer_load_dwordx4 v[248:251], v17, s[36:39], s33 offen sc1
    s_add_u32 s33, s32, 1126656
    buffer_load_dwordx4 v[248:251], v17, s[36:39], s33 offen sc1
    s_add_u32 s33, s32, 1188096
    buffer_load_dwordx4 v[248:251], v17, s[36:39], s33 offen sc1
    buffer_load_dword v248, off, s[36:39], s35 offset:0 sc1
    buffer_load_dword v248, off, s[36:39], s35 offset:3072 sc1
L_ptw_25:
    s_cmp_eq_u32 s78, 3
    s_cbranch_scc0 L_ptx_26
    s_lshl_b32 s32, s28, 2
    s_add_u32 s32, s32, s74
    s_mul_i32 s32, s32, 2560
    s_lshl_b32 s33, s75, 9
    s_add_u32 s32, s32, s33
    s_add_u32 s33, s32, 901376
    buffer_load_dwordx4 v[248:251], v17, s[36:39], s33 offen sc1
    s_add_u32 s33, s32, 983296
    buffer_load_dwordx4 v[248:251], v17, s[36:39], s33 offen sc1
    s_mul_i32 s32, s28, 3
    s_add_u32 s32, s32, s76
    s_mul_i32 s32, s32, 2560
    s_lshl_b32 s33, s77, 9
    s_add_u32 s32, s32, s33
    s_add_u32 s33, s32, 1255680
    buffer_load_dwordx4 v[248:251], v17, s[36:39], s33 offen sc1
    s_add_u32 s33, s32, 1317120
    buffer_load_dwordx4 v[248:251], v17, s[36:39], s33 offen sc1
L_ptx_26:
    s_waitcnt lgkmcnt(0)
    s_barrier
    s_load_dword s93, s[26:27], 0
    v_and_b32 v57, 1, v1
    v_lshlrev_b32 v57, 4, v57
    v_mov_b32 v58, 0xffff
    v_lshlrev_b32 v58, v57, v58
    v_bfe_u32 v59, v1, 1, 2
    v_cmp_eq_u32 vcc, 0, v59
    s_nop 1
    v_cndmask_b32 v8, 0, v58, vcc
    v_cmp_eq_u32 vcc, 1, v59
    s_nop 1
    v_cndmask_b32 v9, 0, v58, vcc
    v_cmp_eq_u32 vcc, 2, v59
    s_nop 1
    v_cndmask_b32 v10, 0, v58, vcc
    v_cmp_eq_u32 vcc, 3, v59
    s_nop 1
    v_cndmask_b32 v11, 0, v58, vcc
    v_and_b32 v48, 0x3f803f80, v8
    v_and_b32 v49, 0x3f803f80, v9
    v_and_b32 v50, 0x3f803f80, v10
    v_and_b32 v51, 0x3f803f80, v11
    v_mul_u32_u24 v3, 2560, v53
    v_lshl_add_u32 v3, v52, 4, v3
    v_lshl_add_u32 v4, v52, 2, v54
    v_lshlrev_b32 v4, 2, v4
    v_bfe_u32 v5, v1, 3, 1
    v_lshlrev_b32 v5, 4, v5
    s_mov_b32 s68, 0xff00ff00
    s_mov_b32 s69, 0xff00ff00
    s_lshl_b32 s32, s78, 2
    v_add_u32 v5, s32, v5
    s_lshl_b32 s32, s78, 10
    v_add_u32 v6, s32, v18
    v_lshlrev_b32 v12, 10, v53
    v_and_b32 v57, 3, v1
    v_lshl_add_u32 v13, v57, 4, v12
    v_add_u32 v13, 128, v13
    s_mul_i32 s32, s78, 192
    s_sub_u32 s32, 768, s32
    v_lshl_add_u32 v14, v57, 4, v12
    v_add_u32 v14, s32, v14
    v_lshl_add_u32 v12, v52, 4, v12
    v_lshlrev_b32 v15, 9, v53
    v_bfe_u32 v58, v1, 2, 1
    v_lshl_add_u32 v15, v58, 8, v15
    v_lshl_add_u32 v15, v57, 4, v15
    v_mov_b32 v59, 0x40000000
    v_cmp_gt_u32 vcc, 5, v53
    s_nop 1
    v_cndmask_b32 v15, v59, v15, vcc
    v_cmp_gt_u32 vcc, 48, v1
    s_nop 1
    v_cndmask_b32 v16, v59, v18, vcc
    s_mov_b32 s84, 1194240
    s_mov_b32 s85, 1376000
    s_mov_b32 s86, 901376
    s_mov_b32 s87, 371968
    s_waitcnt lgkmcnt(0)
    s_add_u32 s93, s93, 1
    s_and_b32 s94, s93, 0xff
    s_and_b32 s95, s93, 0xffff
    v_mov_b32 v57, s94
    v_cmp_gt_u32 vcc, 48, v1
    s_nop 1
    v_cndmask_b32 v19, 0, v57, vcc
    v_cmp_gt_u32 vcc, 40, v1
    s_nop 1
    v_cndmask_b32 v28, 0, v57, vcc
    v_and_b32 v58, 3, v1
    v_mul_u32_u24 v240, 20, v58
    v_min_u32 v58, 2, v58
    v_mul_u32_u24 v241, 20, v58
    v_and_b32 v58, 15, v1
    v_lshlrev_b32 v242, 4, v58
    v_mov_b32 v59, 0x40000000
    v_mov_b32 v56, s93
    v_cmp_gt_u32 vcc, 5, v58
    s_nop 1
    v_cndmask_b32 v242, v59, v242, vcc
    v_cndmask_b32 v243, 0, v56, vcc
    s_getreg_b32 s92, hwreg(HW_REG_XCC_ID, 0, 4)
    s_lshl_b32 s35, s93, 4
    s_or_b32 s92, s92, s35
    s_cmp_eq_u32 s78, 2
    s_cbranch_scc0 L_xcc_27
    s_lshl_b32 s32, s28, 7
    s_lshl_b32 s33, s29, 2
    s_add_u32 s33, s33, s32
    s_add_u32 s33, s33, 370944
    v_mov_b32 v58, s92
    s_mov_b32 exec_lo, 0x1
    s_mov_b32 exec_hi, 0x0
    buffer_store_dword v58, off, s[36:39], s33 sc1
    s_mov_b64 exec, -1
L_xcc_27:
L_W_LOOP:
    s_cmp_eq_u32 s31, 1
    s_cbranch_scc0 L_sg_28
    s_cmp_eq_u32 s78, 1
    s_cbranch_scc0 L_sg_28
    s_mul_i32 s32, s28, 15360
    s_lshr_b32 s33, s29, 3
    s_mul_i32 s33, s33, 768
    s_add_u32 s80, s32, s33
    s_mul_i32 s32, s31, 122880
    s_add_u32 s82, s80, s32
    s_add_u32 s82, s82, 256
    s_cmp_eq_u32 s79, 1
    s_cselect_b32 s32, 0, 2143232
    s_add_u32 s80, s80, s32
    s_mov_b32 s34, 0x20000
L_sg_29:
    s_add_u32 s35, s80, 246016
    buffer_load_dwordx4 v[192:195], v16, s[36:39], s35 offen sc1
    s_add_u32 s35, s80, 249088
    buffer_load_dwordx4 v[196:199], v16, s[36:39], s35 offen sc1
    s_add_u32 s35, s80, 252160
    buffer_load_dwordx4 v[200:203], v16, s[36:39], s35 offen sc1
    s_add_u32 s35, s80, 255232
    buffer_load_dwordx4 v[204:207], v16, s[36:39], s35 offen sc1
    s_add_u32 s35, s80, 258304
    buffer_load_dwordx4 v[208:211], v16, s[36:39], s35 offen sc1
    s_waitcnt vmcnt(0)
    v_xor_b32 v192, v19, v192
    v_xor_b32 v196, v19, v196
    v_xor_b32 v200, v19, v200
    v_xor_b32 v204, v19, v204
    v_xor_b32 v208, v19, v208
    v_or3_b32 v252, v192, v196, v200
    v_or3_b32 v252, v252, v204, v208
    v_cmp_ne_u32_sdwa vcc, v252, v7 src0_sel:BYTE_0 src1_sel:DWORD
    s_cbranch_vccz L_pq_30
    s_sub_u32 s34, s34, 1
    s_cbranch_scc0 L_sg_29
L_pq_30:
    v_pk_add_f32 v[192:193], v[192:193], v[196:197]
    v_pk_add_f32 v[200:201], v[200:201], v[204:205]
    v_pk_add_f32 v[194:195], v[194:195], v[198:199]
    v_pk_add_f32 v[202:203], v[202:203], v[206:207]
    v_pk_add_f32 v[192:193], v[192:193], v[208:209]
    v_pk_add_f32 v[194:195], v[194:195], v[210:211]
    v_pk_add_f32 v[192:193], v[192:193], v[200:201]
    v_pk_add_f32 v[194:195], v[194:195], v[202:203]
    v_mov_b32 v20, v192
    v_mov_b32 v21, v193
    v_mov_b32 v22, v194
    v_mov_b32 v23, v195
L_sg_28:
    s_cmp_ge_u32 s29, 2
    s_cbranch_scc0 L_noq_31
    s_cmp_eq_u32 s31, 0
    s_cbranch_scc1 L_x0_32
    s_lshl_b32 s32, s72, 9
    s_lshl_b32 s33, s78, 7
    s_add_u32 s32, s32, s33
    s_add_u32 s82, s84, s32
    s_add_u32 s83, s85, s32
    s_add_u32 s80, s82, 20480
    s_add_u32 s81, s82, 40960
    s_add_u32 s33, s82, 61440
    s_cmp_eq_u32 s79, 1
    s_cbranch_scc0 L_hw_34
    s_lshl_b32 s32, s72, 2
    s_add_u32 s32, s32, s89
    s_mov_b32 s34, 0x20000
    buffer_load_dword v244, v241, s[36:39], s32 offen sc1
    s_sleep 2
L_hw_35:
    buffer_load_dword v245, v241, s[36:39], s32 offen sc1
    s_waitcnt vmcnt(1)
    v_cmp_ne_u32 vcc, s93, v244
    s_cbranch_vccnz L_hwa_36
    s_branch L_hwd_38
L_hwa_36:
    buffer_load_dword v244, v241, s[36:39], s32 offen sc1
    s_waitcnt vmcnt(1)
    v_cmp_ne_u32 vcc, s93, v245
    s_cbranch_vccnz L_hwb_37
    s_branch L_hwd_38
L_hwb_37:
    s_sub_u32 s34, s34, 1
    s_cbranch_scc0 L_hw_35
L_hwd_38:
L_hw_34:
    s_mov_b32 s34, 0x20000
    buffer_load_dwordx4 v[192:195], v3, s[36:39], s82 offen sc1
    buffer_load_dwordx4 v[196:199], v3, s[36:39], s80 offen sc1
    buffer_load_dwordx4 v[200:203], v3, s[36:39], s81 offen sc1
    buffer_load_dword v208, v4, s[36:39], s83 offen sc1
    s_sleep 5
L_xg_39:
    buffer_load_dwordx4 v[212:215], v3, s[36:39], s82 offen sc1
    buffer_load_dwordx4 v[216:219], v3, s[36:39], s80 offen sc1
    buffer_load_dwordx4 v[220:223], v3, s[36:39], s81 offen sc1
    buffer_load_dword v228, v4, s[36:39], s83 offen sc1
    s_waitcnt vmcnt(4)
    v_xor_b32 v192, s94, v192
    v_xor_b32 v196, s94, v196
    v_xor_b32 v200, s94, v200
    v_xor_b32 v208, s95, v208
    v_or3_b32 v209, v192, v196, v200
    v_and_b32 v209, 0xff, v209
    v_and_or_b32 v209, v208, v63, v209
    v_cmp_ne_u32 vcc, 0, v209
    s_cbranch_vccnz L_xga_40
    v_pk_add_f32 v[192:193], v[192:193], v[196:197]
    v_pk_add_f32 v[194:195], v[194:195], v[198:199]
    v_pk_add_f32 v[192:193], v[192:193], v[200:201]
    v_pk_add_f32 v[194:195], v[194:195], v[202:203]
    s_nop 1
    v_permlane32_swap_b32 v192, v194
    v_permlane32_swap_b32 v193, v195
    v_add_f32 v192, v192, v194
    v_add_f32 v193, v193, v195
    s_nop 1
    v_permlane16_swap_b32 v192, v193
    v_add_f32 v192, v192, v193
    s_nop 1
    v_add_f32_dpp v192, v192, v192 row_ror:8 row_mask:0xf bank_mask:0xf
    v_add_f32 v29, v192, v208
    s_branch L_xgd_42
L_xga_40:
    buffer_load_dwordx4 v[192:195], v3, s[36:39], s82 offen sc1
    buffer_load_dwordx4 v[196:199], v3, s[36:39], s80 offen sc1
    buffer_load_dwordx4 v[200:203], v3, s[36:39], s81 offen sc1
    buffer_load_dword v208, v4, s[36:39], s83 offen sc1
    s_waitcnt vmcnt(4)
    v_xor_b32 v212, s94, v212
    v_xor_b32 v216, s94, v216
    v_xor_b32 v220, s94, v220
    v_xor_b32 v228, s95, v228
    v_or3_b32 v229, v212, v216, v220
    v_and_b32 v229, 0xff, v229
    v_and_or_b32 v229, v228, v63, v229
    v_cmp_ne_u32 vcc, 0, v229
    s_cbranch_vccnz L_xgb_41
    v_pk_add_f32 v[212:213], v[212:213], v[216:217]
    v_pk_add_f32 v[214:215], v[214:215], v[218:219]
    v_pk_add_f32 v[212:213], v[212:213], v[220:221]
    v_pk_add_f32 v[214:215], v[214:215], v[222:223]
    s_nop 1
    v_permlane32_swap_b32 v212, v214
    v_permlane32_swap_b32 v213, v215
    v_add_f32 v212, v212, v214
    v_add_f32 v213, v213, v215
    s_nop 1
    v_permlane16_swap_b32 v212, v213
    v_add_f32 v212, v212, v213
    s_nop 1
    v_add_f32_dpp v212, v212, v212 row_ror:8 row_mask:0xf bank_mask:0xf
    v_add_f32 v29, v212, v228
    s_branch L_xgd_42
L_xgb_41:
    s_sub_u32 s34, s34, 1
    s_cbranch_scc0 L_xg_39
L_xgd_42:
    s_cmp_eq_u32 s31, 2
    s_cbranch_scc1 L_FINAL
    s_branch L_xready_33
L_x0_32:
    s_cmp_eq_u32 s78, 2
    s_cbranch_scc0 L_xa_43
    s_waitcnt vmcnt(17)
    s_branch L_xc_45
L_xa_43:
    s_cmp_eq_u32 s78, 3
    s_cbranch_scc0 L_xb_44
    s_waitcnt vmcnt(4)
    s_branch L_xc_45
L_xb_44:
    s_waitcnt vmcnt(0)
L_xc_45:
    v_lshlrev_b32 v192, 16, v25
    v_mov_b32 v234, 0x3f803f80
    v_dot2_f32_bf16 v232, v224, v234, 0
    v_dot2_f32_bf16 v233, v224, v224, 0
    s_nop 1
    v_dot2c_f32_bf16 v232, v225, v234
    v_dot2c_f32_bf16 v233, v225, v225
    v_dot2c_f32_bf16 v232, v226, v234
    v_dot2c_f32_bf16 v233, v226, v226
    v_dot2c_f32_bf16 v232, v227, v234
    v_dot2c_f32_bf16 v233, v227, v227
    v_dot2c_f32_bf16 v232, v228, v234
    v_dot2c_f32_bf16 v233, v228, v228
    s_nop 1
    v_add_f32_dpp v232, v232, v232 quad_perm:[1,0,3,2] row_mask:0xf bank_mask:0xf
    v_add_f32_dpp v233, v233, v233 quad_perm:[1,0,3,2] row_mask:0xf bank_mask:0xf
    s_nop 0
    v_add_f32_dpp v232, v232, v232 quad_perm:[2,3,0,1] row_mask:0xf bank_mask:0xf
    v_add_f32_dpp v233, v233, v233 quad_perm:[2,3,0,1] row_mask:0xf bank_mask:0xf
    s_nop 0
    v_add_f32_dpp v232, v232, v232 row_half_mirror row_mask:0xf bank_mask:0xf
    v_add_f32_dpp v233, v233, v233 row_half_mirror row_mask:0xf bank_mask:0xf
    s_nop 0
    v_add_f32_dpp v232, v232, v232 row_ror:8 row_mask:0xf bank_mask:0xf
    v_mov_b32 v234, v232
    s_nop 1
    v_permlane16_swap_b32 v232, v234
    v_add_f32 v232, v232, v234
    v_mov_b32 v234, v232
    s_nop 1
    v_permlane32_swap_b32 v232, v234
    v_add_f32 v232, v232, v234
    v_add_f32_dpp v233, v233, v233 row_ror:8 row_mask:0xf bank_mask:0xf
    v_mov_b32 v234, v233
    s_nop 1
    v_permlane16_swap_b32 v233, v234
    v_add_f32 v233, v233, v234
    v_mov_b32 v234, v233
    s_nop 1
    v_permlane32_swap_b32 v233, v234
    v_add_f32 v233, v233, v234
    v_mul_f32 v232, 0x3acccccd, v232
    v_mul_f32 v233, 0x3acccccd, v233
    v_fma_f32 v233, -v232, v232, v233
    v_add_f32 v233, 0x3727c5ac, v233
    v_rsq_f32 v233, v233
    v_mov_b32 v25, v192
    v_sub_f32 v193, v192, v232
    v_mul_f32 v193, v193, v233
    v_cvt_pk_bf16_f32 v26, v193, v193
    s_branch L_xr2_46
L_xready_33:
    v_cvt_pk_bf16_f32 v26, v29, v29
    v_and_b32 v25, 0xffff0000, v26
L_xr2_46:
    s_nop 0
    v_and_b32_dpp v32, v26, v8 row_newbcast:0 row_mask:0xf bank_mask:0xf
    v_and_b32_dpp v33, v26, v9 row_newbcast:0 row_mask:0xf bank_mask:0xf
    v_and_b32_dpp v34, v26, v10 row_newbcast:0 row_mask:0xf bank_mask:0xf
    v_and_b32_dpp v35, v26, v11 row_newbcast:0 row_mask:0xf bank_mask:0xf
    v_and_b32_dpp v36, v26, v8 row_newbcast:1 row_mask:0xf bank_mask:0xf
    v_and_b32_dpp v37, v26, v9 row_newbcast:1 row_mask:0xf bank_mask:0xf
    v_and_b32_dpp v38, v26, v10 row_newbcast:1 row_mask:0xf bank_mask:0xf
    v_and_b32_dpp v39, v26, v11 row_newbcast:1 row_mask:0xf bank_mask:0xf
    v_mfma_f32_16x16x32_bf16 v[40:43], v[32:35], v[64:67], 0
    v_mul_f32 v31, v25, v25
    v_and_b32_dpp v32, v26, v8 row_newbcast:2 row_mask:0xf bank_mask:0xf
    v_and_b32_dpp v33, v26, v9 row_newbcast:2 row_mask:0xf bank_mask:0xf
    v_and_b32_dpp v34, v26, v10 row_newbcast:2 row_mask:0xf bank_mask:0xf
    v_and_b32_dpp v35, v26, v11 row_newbcast:2 row_mask:0xf bank_mask:0xf
    v_mfma_f32_16x16x32_bf16 v[40:43], v[36:39], v[68:71], v[40:43]
    v_cndmask_b32 v30, v25, v31, s[68:69]
    v_and_b32_dpp v36, v26, v8 row_newbcast:3 row_mask:0xf bank_mask:0xf
    v_and_b32_dpp v37, v26, v9 row_newbcast:3 row_mask:0xf bank_mask:0xf
    v_and_b32_dpp v38, v26, v10 row_newbcast:3 row_mask:0xf bank_mask:0xf
    v_and_b32_dpp v39, v26, v11 row_newbcast:3 row_mask:0xf bank_mask:0xf
    v_mfma_f32_16x16x32_bf16 v[40:43], v[32:35], v[72:75], v[40:43]
    v_add_f32_dpp v30, v30, v30 quad_perm:[1,0,3,2] row_mask:0xf bank_mask:0xf
    v_and_b32_dpp v32, v26, v8 row_newbcast:4 row_mask:0xf bank_mask:0xf
    v_and_b32_dpp v33, v26, v9 row_newbcast:4 row_mask:0xf bank_mask:0xf
    v_and_b32_dpp v34, v26, v10 row_newbcast:4 row_mask:0xf bank_mask:0xf
    v_and_b32_dpp v35, v26, v11 row_newbcast:4 row_mask:0xf bank_mask:0xf
    v_mfma_f32_16x16x32_bf16 v[40:43], v[36:39], v[76:79], v[40:43]
    v_add_f32_dpp v30, v30, v30 quad_perm:[2,3,0,1] row_mask:0xf bank_mask:0xf
    v_and_b32_dpp v36, v26, v8 row_newbcast:5 row_mask:0xf bank_mask:0xf
    v_and_b32_dpp v37, v26, v9 row_newbcast:5 row_mask:0xf bank_mask:0xf
    v_and_b32_dpp v38, v26, v10 row_newbcast:5 row_mask:0xf bank_mask:0xf
    v_and_b32_dpp v39, v26, v11 row_newbcast:5 row_mask:0xf bank_mask:0xf
    v_mfma_f32_16x16x32_bf16 v[40:43], v[32:35], v[80:83], v[40:43]
    v_add_f32_dpp v30, v30, v30 row_half_mirror row_mask:0xf bank_mask:0xf
    v_and_b32_dpp v32, v26, v8 row_newbcast:6 row_mask:0xf bank_mask:0xf
    v_and_b32_dpp v33, v26, v9 row_newbcast:6 row_mask:0xf bank_mask:0xf
    v_and_b32_dpp v34, v26, v10 row_newbcast:6 row_mask:0xf bank_mask:0xf
    v_and_b32_dpp v35, v26, v11 row_newbcast:6 row_mask:0xf bank_mask:0xf
    v_mfma_f32_16x16x32_bf16 v[40:43], v[36:39], v[84:87], v[40:43]
    v_mov_b32 v31, v30
    v_and_b32_dpp v36, v26, v8 row_newbcast:7 row_mask:0xf bank_mask:0xf
    v_and_b32_dpp v37, v26, v9 row_newbcast:7 row_mask:0xf bank_mask:0xf
    v_and_b32_dpp v38, v26, v10 row_newbcast:7 row_mask:0xf bank_mask:0xf
    v_and_b32_dpp v39, v26, v11 row_newbcast:7 row_mask:0xf bank_mask:0xf
    v_mfma_f32_16x16x32_bf16 v[40:43], v[32:35], v[88:91], v[40:43]
    v_permlane16_swap_b32 v30, v31
    v_mfma_f32_16x16x32_bf16 v[40:43], v[36:39], v[92:95], v[40:43]
    v_add_f32 v30, v30, v31
    v_mov_b32 v31, v30
    s_nop 1
    v_permlane32_swap_b32 v30, v31
    v_add_f32 v30, v30, v31
    s_cmp_eq_u32 s31, 0
    s_cbranch_scc0 L_nos_47
    v_and_b32 v48, 0x3f803f80, v8
    v_and_b32 v49, 0x3f803f80, v9
    v_and_b32 v50, 0x3f803f80, v10
    v_and_b32 v51, 0x3f803f80, v11
    s_nop 1
    v_mfma_f32_16x16x32_bf16 v[44:47], v[48:51], v[64:67], 0
    v_mfma_f32_16x16x32_bf16 v[44:47], v[48:51], v[68:71], v[44:47]
    v_mfma_f32_16x16x32_bf16 v[44:47], v[48:51], v[72:75], v[44:47]
    v_mfma_f32_16x16x32_bf16 v[44:47], v[48:51], v[76:79], v[44:47]
    v_mfma_f32_16x16x32_bf16 v[44:47], v[48:51], v[80:83], v[44:47]
    v_mfma_f32_16x16x32_bf16 v[44:47], v[48:51], v[84:87], v[44:47]
    v_mfma_f32_16x16x32_bf16 v[44:47], v[48:51], v[88:91], v[44:47]
    v_mfma_f32_16x16x32_bf16 v[44:47], v[48:51], v[92:95], v[44:47]
    s_mov_b32 exec_lo, 0x0
    s_mov_b32 exec_hi, 0xffffffff
    s_nop 5
    v_mov_b32 v40, v44
    v_mov_b32 v41, v45
    v_mov_b32 v42, v46
    v_mov_b32 v43, v47
    s_mov_b64 exec, -1
L_nos_47:
    ds_write_b128 v6, v[40:43] offset:0
    s_mov_b32 exec_lo, 0x101
    s_mov_b32 exec_hi, 0x0
    ds_write_b32 v5, v30 offset:4096
    s_mov_b64 exec, -1
    s_branch L_noq2_48
L_noq_31:
L_noq2_48:
    s_cmp_eq_u32 s31, 0
    s_cbranch_scc0 L_qs1_49
    s_waitcnt lgkmcnt(0)
    v_mov_b32 v52, 1
    s_lshl_b32 s32, s78, 2
    v_mov_b32 v53, s32
    s_mov_b32 exec_lo, 0x1
    s_mov_b32 exec_hi, 0x0
    ds_write_b32 v53, v52 offset:22224
    s_mov_b64 exec, -1
    s_cmp_eq_u32 s78, 0
    s_cbranch_scc0 L_qsd_50
    s_mov_b32 s34, 0x100000
L_ls_51:
    ds_read_b128 v[56:59], v7 offset:22224
    s_waitcnt lgkmcnt(0)
    v_min3_u32 v56, v56, v57, v58
    v_min_u32 v56, v56, v59
    v_cmp_eq_u32 vcc, 1, v56
    s_cbranch_vccnz L_lsd_52
    s_sub_u32 s34, s34, 1
    s_cbranch_scc0 L_ls_51
L_lsd_52:
    s_branch L_qsd_50
L_qs1_49:
    s_waitcnt lgkmcnt(0)
    s_barrier
L_qsd_50:
    s_cmp_eq_u32 s78, 0
    s_cbranch_scc0 L_wq0_53
    s_cmp_ge_u32 s29, 2
    s_cbranch_scc0 L_wq0_53
    ds_read_b128 v[32:35], v18 offset:0
    ds_read_b128 v[36:39], v18 offset:1024
    ds_read_b128 v[40:43], v18 offset:2048
    ds_read_b128 v[44:47], v18 offset:3072
    v_mov_b32 v56, 0
    ds_read_b128 v[48:51], v56 offset:4096
    ds_read_b128 v[52:55], v56 offset:4112
    v_mov_b32 v57, v17
    s_cmp_eq_u32 s31, 0
    s_cbranch_scc0 L_pub1_54
    s_mov_b32 exec_lo, 0x0
    s_mov_b32 exec_hi, 0xffffffff
    v_add_u32 v57, 245760, v57
    s_mov_b64 exec, -1
    s_branch L_pub2_55
L_pub1_54:
    s_mov_b32 exec_lo, 0xffffffff
    s_mov_b32 exec_hi, 0x0
L_pub2_55:
    s_waitcnt lgkmcnt(2)
    v_pk_add_f32 v[32:33], v[32:33], v[36:37]
    v_pk_add_f32 v[40:41], v[40:41], v[44:45]
    v_pk_add_f32 v[34:35], v[34:35], v[38:39]
    v_pk_add_f32 v[42:43], v[42:43], v[46:47]
    v_pk_add_f32 v[32:33], v[32:33], v[40:41]
    v_pk_add_f32 v[34:35], v[34:35], v[42:43]
    v_bfi_b32 v32, v62, s93, v32
    s_cmp_eq_u32 s31, 0
    s_cbranch_scc0 L_du1_56
    buffer_store_dwordx4 v[32:35], v57, s[36:39], s90 offen
    s_add_u32 s35, s90, 2143232
    buffer_store_dwordx4 v[32:35], v57, s[36:39], s35 offen sc1
    s_branch L_du2_57
L_du1_56:
    s_cmp_eq_u32 s79, 1
    s_cbranch_scc0 L_sts_58
    buffer_store_dwordx4 v[32:35], v57, s[36:39], s90 offen
L_stb_59:
L_du2_57:
    s_cmp_eq_u32 s73, 0
    s_cbranch_scc0 L_nost_60
    s_cmp_lg_u32 s31, 0
    s_cbranch_scc0 L_nost_60
    s_waitcnt lgkmcnt(0)
    s_mov_b32 exec_lo, 0x1
    s_mov_b32 exec_hi, 0x0
    v_pk_add_f32 v[48:49], v[48:49], v[50:51]
    v_pk_add_f32 v[52:53], v[52:53], v[54:55]
    v_add_f32 v48, v48, v49
    v_add_f32 v49, v52, v53
    v_mov_b32 v50, s93
    v_mov_b32 v51, s93
    s_cmp_eq_u32 s79, 1
    s_cbranch_scc0 L_sts_61
    buffer_store_dwordx4 v[48:51], off, s[36:39], s91
L_stb_62:
L_nost_60:
    s_mov_b64 exec, -1
L_wq0_53:
    s_cmp_eq_u32 s28, 0
    s_cbranch_scc0 L_xr1_63
    s_cmp_eq_u32 s73, 0
    s_cbranch_scc0 L_xr1_63
    s_cmp_ge_u32 s29, 2
    s_cbranch_scc0 L_xr1_63
    s_lshl_b32 s32, s72, 9
    s_lshl_b32 s33, s78, 7
    s_add_u32 s32, s32, s33
    s_add_u32 s32, s32, s87
    v_or_b32 v52, s95, v25
    s_mov_b32 exec_lo, 0xff00ff
    s_mov_b32 exec_hi, 0xff00ff
    buffer_store_dword v52, v4, s[36:39], s32 offen sc1
    s_mov_b64 exec, -1
L_xr1_63:
    s_cmp_eq_u32 s31, 0
    s_cbranch_scc0 L_xcc_64
    s_cmp_eq_u32 s78, 3
    s_cbranch_scc0 L_xcc_64
    v_and_b32 v193, 31, v1
    v_lshlrev_b32 v193, 2, v193
    s_lshl_b32 s83, s28, 7
    s_add_u32 s83, s83, 370944
    s_mov_b32 s34, 0x20000
L_xc_65:
    buffer_load_dword v194, v193, s[36:39], s83 offen sc1
    s_waitcnt vmcnt(0)
    v_xor_b32 v194, s92, v194
    v_lshrrev_b32 v195, 4, v194
    v_cmp_ne_u32 vcc, 0, v195
    s_cbranch_vccz L_pq_66
    s_sub_u32 s34, s34, 1
    s_cbranch_scc0 L_xc_65
L_pq_66:
    v_cmp_ne_u32 vcc, 0, v194
    s_nop 0
    s_cmp_eq_u64 vcc, 0
    s_cselect_b32 s32, 1, 0
    s_or_b32 s32, s32, 2
    v_mov_b32 v192, s32
    s_mov_b32 exec_lo, 0x1
    s_mov_b32 exec_hi, 0x0
    ds_write_b32 v7, v192 offset:22208
    s_mov_b64 exec, -1
L_xcc_64:
    s_cmp_eq_u32 s78, 1
    s_cbranch_scc0 L_qg_67
    s_mul_i32 s32, s28, 15360
    s_lshr_b32 s33, s29, 3
    s_mul_i32 s33, s33, 768
    s_add_u32 s80, s32, s33
    s_mul_i32 s32, s31, 122880
    s_add_u32 s82, s80, s32
    s_add_u32 s82, s82, 256
    s_cmp_eq_u32 s31, 0
    s_cbranch_scc0 L_q1_68
    s_add_u32 s32, s82, 3072
    s_add_u32 s33, s82, 6144
    s_add_u32 s80, s82, 9216
    s_add_u32 s81, s82, 12288
    s_mov_b32 s83, 0
    s_mov_b32 s34, 0x20000
    buffer_load_dwordx4 v[192:195], v16, s[36:39], s82 offen sc1
    buffer_load_dwordx4 v[196:199], v16, s[36:39], s32 offen sc1
    buffer_load_dwordx4 v[200:203], v16, s[36:39], s33 offen sc1
    buffer_load_dwordx4 v[204:207], v16, s[36:39], s80 offen sc1
    buffer_load_dwordx4 v[208:211], v16, s[36:39], s81 offen sc1
L_q0l_70:
    buffer_load_dwordx4 v[212:215], v16, s[36:39], s82 offen sc1
    buffer_load_dwordx4 v[216:219], v16, s[36:39], s32 offen sc1
    buffer_load_dwordx4 v[220:223], v16, s[36:39], s33 offen sc1
    buffer_load_dwordx4 v[224:227], v16, s[36:39], s80 offen sc1
    buffer_load_dwordx4 v[228:231], v16, s[36:39], s81 offen sc1
    s_waitcnt vmcnt(5)
    v_xor_b32 v192, v19, v192
    v_xor_b32 v196, v19, v196
    v_xor_b32 v200, v19, v200
    v_xor_b32 v204, v19, v204
    v_xor_b32 v208, v19, v208
    v_or3_b32 v252, v192, v196, v200
    v_or3_b32 v252, v252, v204, v208
    v_cmp_ne_u32_sdwa vcc, v252, v7 src0_sel:BYTE_0 src1_sel:DWORD
    s_cbranch_vccnz L_q0fa_71
    v_pk_add_f32 v[192:193], v[192:193], v[196:197]
    v_pk_add_f32 v[200:201], v[200:201], v[204:205]
    v_pk_add_f32 v[194:195], v[194:195], v[198:199]
    v_pk_add_f32 v[202:203], v[202:203], v[206:207]
    v_pk_add_f32 v[192:193], v[192:193], v[208:209]
    v_pk_add_f32 v[194:195], v[194:195], v[210:211]
    v_pk_add_f32 v[52:53], v[192:193], v[200:201]
    v_pk_add_f32 v[54:55], v[194:195], v[202:203]
    s_branch L_qd_69
L_q0fa_71:
    buffer_load_dwordx4 v[192:195], v16, s[36:39], s82 offen sc1
    buffer_load_dwordx4 v[196:199], v16, s[36:39], s32 offen sc1
    buffer_load_dwordx4 v[200:203], v16, s[36:39], s33 offen sc1
    buffer_load_dwordx4 v[204:207], v16, s[36:39], s80 offen sc1
    buffer_load_dwordx4 v[208:211], v16, s[36:39], s81 offen sc1
    s_waitcnt vmcnt(5)
    v_xor_b32 v212, v19, v212
    v_xor_b32 v216, v19, v216
    v_xor_b32 v220, v19, v220
    v_xor_b32 v224, v19, v224
    v_xor_b32 v228, v19, v228
    v_or3_b32 v252, v212, v216, v220
    v_or3_b32 v252, v252, v224, v228
    v_cmp_ne_u32_sdwa vcc, v252, v7 src0_sel:BYTE_0 src1_sel:DWORD
    s_cbranch_vccnz L_q0fb_72
    v_pk_add_f32 v[212:213], v[212:213], v[216:217]
    v_pk_add_f32 v[220:221], v[220:221], v[224:225]
    v_pk_add_f32 v[214:215], v[214:215], v[218:219]
    v_pk_add_f32 v[222:223], v[222:223], v[226:227]
    v_pk_add_f32 v[212:213], v[212:213], v[228:229]
    v_pk_add_f32 v[214:215], v[214:215], v[230:231]
    v_pk_add_f32 v[52:53], v[212:213], v[220:221]
    v_pk_add_f32 v[54:55], v[214:215], v[222:223]
    s_branch L_qd_69
L_q0fb_72:
    s_cmp_eq_u32 s83, 0
    s_cbranch_scc0 L_nosw_74
    ds_read_b32 v253, v7 offset:22208
    s_waitcnt lgkmcnt(0)
    v_readfirstlane_b32 s35, v253
    s_nop 0
    s_cmp_eq_u32 s35, 2
    s_cbranch_scc0 L_nosw_74
    s_mov_b32 s83, 1
    s_add_u32 s82, s82, 2143232
    s_add_u32 s32, s82, 3072
    s_add_u32 s33, s82, 6144
    s_add_u32 s80, s82, 9216
    s_add_u32 s81, s82, 12288
L_nosw_74:
    s_sub_u32 s34, s34, 1
    s_cbranch_scc0 L_q0l_70
    s_branch L_qd_69
L_q1_68:
    s_mul_i32 s32, s31, 1024
    s_lshl_b32 s33, s28, 7
    s_add_u32 s32, s32, s33
    s_add_u32 s83, s32, 368896
    s_add_u32 s32, s82, 3072
    s_add_u32 s33, s82, 6144
    s_add_u32 s80, s82, 9216
    s_add_u32 s81, s82, 12288
    s_mov_b32 s34, 0x20000
    buffer_load_dwordx4 v[192:195], v16, s[36:39], s82 offen sc1
    buffer_load_dwordx4 v[196:199], v16, s[36:39], s32 offen sc1
    buffer_load_dwordx4 v[200:203], v16, s[36:39], s33 offen sc1
    buffer_load_dwordx4 v[204:207], v16, s[36:39], s80 offen sc1
    buffer_load_dwordx4 v[208:211], v16, s[36:39], s81 offen sc1
    buffer_load_dwordx4 v[212:215], v242, s[36:39], s83 offen sc1
    s_sleep 2
L_qt_75:
    buffer_load_dwordx4 v[216:219], v16, s[36:39], s82 offen sc1
    buffer_load_dwordx4 v[220:223], v16, s[36:39], s32 offen sc1
    buffer_load_dwordx4 v[224:227], v16, s[36:39], s33 offen sc1
    buffer_load_dwordx4 v[228:231], v16, s[36:39], s80 offen sc1
    buffer_load_dwordx4 v[232:235], v16, s[36:39], s81 offen sc1
    buffer_load_dwordx4 v[236:239], v242, s[36:39], s83 offen sc1
    s_waitcnt vmcnt(6)
    v_xor_b32 v192, v19, v192
    v_xor_b32 v196, v19, v196
    v_xor_b32 v200, v19, v200
    v_xor_b32 v204, v19, v204
    v_xor_b32 v208, v19, v208
    v_xor_b32 v214, v243, v214
    v_or3_b32 v59, v192, v196, v200
    v_or3_b32 v59, v59, v204, v208
    v_and_b32 v59, 0xff, v59
    v_or_b32 v59, v59, v214
    v_cmp_ne_u32 vcc, 0, v59
    s_cbranch_vccnz L_qta_76
    v_add_f32_dpp v212, v212, v212 row_ror:1 row_mask:0xf bank_mask:0xf
    v_pk_add_f32 v[192:193], v[192:193], v[196:197]
    v_add_f32_dpp v213, v213, v213 row_ror:1 row_mask:0xf bank_mask:0xf
    v_pk_add_f32 v[200:201], v[200:201], v[204:205]
    v_add_f32_dpp v212, v212, v212 row_ror:2 row_mask:0xf bank_mask:0xf
    v_pk_add_f32 v[194:195], v[194:195], v[198:199]
    v_add_f32_dpp v213, v213, v213 row_ror:2 row_mask:0xf bank_mask:0xf
    v_pk_add_f32 v[202:203], v[202:203], v[206:207]
    v_add_f32_dpp v212, v212, v212 row_ror:4 row_mask:0xf bank_mask:0xf
    v_pk_add_f32 v[192:193], v[192:193], v[208:209]
    v_add_f32_dpp v213, v213, v213 row_ror:4 row_mask:0xf bank_mask:0xf
    v_pk_add_f32 v[194:195], v[194:195], v[210:211]
    v_add_f32_dpp v212, v212, v212 row_ror:8 row_mask:0xf bank_mask:0xf
    v_pk_add_f32 v[52:53], v[192:193], v[200:201]
    v_add_f32_dpp v213, v213, v213 row_ror:8 row_mask:0xf bank_mask:0xf
    v_pk_add_f32 v[54:55], v[194:195], v[202:203]
    v_mul_f32 v212, 0x3acccccd, v212
    v_mul_f32 v213, 0x3acccccd, v213
    v_fma_f32 v213, -v212, v212, v213
    v_add_f32 v213, 0x3727c5ac, v213
    v_rsq_f32 v213, v213
    v_fma_f32 v52, -v212, v20, v52
    v_fma_f32 v53, -v212, v21, v53
    v_fma_f32 v54, -v212, v22, v54
    v_fma_f32 v55, -v212, v23, v55
    v_mul_f32 v52, v52, v213
    v_mul_f32 v53, v53, v213
    v_mul_f32 v54, v54, v213
    v_mul_f32 v55, v55, v213
    s_branch L_qtd_78
L_qta_76:
    buffer_load_dwordx4 v[192:195], v16, s[36:39], s82 offen sc1
    buffer_load_dwordx4 v[196:199], v16, s[36:39], s32 offen sc1
    buffer_load_dwordx4 v[200:203], v16, s[36:39], s33 offen sc1
    buffer_load_dwordx4 v[204:207], v16, s[36:39], s80 offen sc1
    buffer_load_dwordx4 v[208:211], v16, s[36:39], s81 offen sc1
    buffer_load_dwordx4 v[212:215], v242, s[36:39], s83 offen sc1
    s_waitcnt vmcnt(6)
    v_xor_b32 v216, v19, v216
    v_xor_b32 v220, v19, v220
    v_xor_b32 v224, v19, v224
    v_xor_b32 v228, v19, v228
    v_xor_b32 v232, v19, v232
    v_xor_b32 v238, v243, v238
    v_or3_b32 v59, v216, v220, v224
    v_or3_b32 v59, v59, v228, v232
    v_and_b32 v59, 0xff, v59
    v_or_b32 v59, v59, v238
    v_cmp_ne_u32 vcc, 0, v59
    s_cbranch_vccnz L_qtb_77
    v_add_f32_dpp v236, v236, v236 row_ror:1 row_mask:0xf bank_mask:0xf
    v_pk_add_f32 v[216:217], v[216:217], v[220:221]
    v_add_f32_dpp v237, v237, v237 row_ror:1 row_mask:0xf bank_mask:0xf
    v_pk_add_f32 v[224:225], v[224:225], v[228:229]
    v_add_f32_dpp v236, v236, v236 row_ror:2 row_mask:0xf bank_mask:0xf
    v_pk_add_f32 v[218:219], v[218:219], v[222:223]
    v_add_f32_dpp v237, v237, v237 row_ror:2 row_mask:0xf bank_mask:0xf
    v_pk_add_f32 v[226:227], v[226:227], v[230:231]
    v_add_f32_dpp v236, v236, v236 row_ror:4 row_mask:0xf bank_mask:0xf
    v_pk_add_f32 v[216:217], v[216:217], v[232:233]
    v_add_f32_dpp v237, v237, v237 row_ror:4 row_mask:0xf bank_mask:0xf
    v_pk_add_f32 v[218:219], v[218:219], v[234:235]
    v_add_f32_dpp v236, v236, v236 row_ror:8 row_mask:0xf bank_mask:0xf
    v_pk_add_f32 v[52:53], v[216:217], v[224:225]
    v_add_f32_dpp v237, v237, v237 row_ror:8 row_mask:0xf bank_mask:0xf
    v_pk_add_f32 v[54:55], v[218:219], v[226:227]
    v_mul_f32 v236, 0x3acccccd, v236
    v_mul_f32 v237, 0x3acccccd, v237
    v_fma_f32 v237, -v236, v236, v237
    v_add_f32 v237, 0x3727c5ac, v237
    v_rsq_f32 v237, v237
    v_fma_f32 v52, -v236, v20, v52
    v_fma_f32 v53, -v236, v21, v53
    v_fma_f32 v54, -v236, v22, v54
    v_fma_f32 v55, -v236, v23, v55
    v_mul_f32 v52, v52, v237
    v_mul_f32 v53, v53, v237
    v_mul_f32 v54, v54, v237
    v_mul_f32 v55, v55, v237
    s_branch L_qtd_78
L_qtb_77:
    s_sub_u32 s34, s34, 1
    s_cbranch_scc0 L_qt_75
L_qtd_78:
L_qd_69:
    v_lshlrev_b32 v58, 3, v1
    v_cvt_pk_bf16_f32 v56, v52, v53
    v_cvt_pk_bf16_f32 v57, v54, v55
    s_mov_b32 exec_lo, 0xffffffff
    s_mov_b32 exec_hi, 0xffff
    ds_write_b64 v58, v[56:57] offset:21760
    s_mov_b64 exec, -1
L_qg_67:
    s_waitcnt lgkmcnt(0)
    s_barrier
    s_cmp_eq_u32 s31, 0
    s_cbranch_scc0 L_wl_79
    ds_read_b32 v253, v7 offset:22208
    s_waitcnt lgkmcnt(0)
    v_readfirstlane_b32 s79, v253
    s_nop 0
    s_and_b32 s79, s79, 1
    s_barrier
    s_waitcnt vmcnt(0)
    s_cmp_ge_u32 s29, 12
    s_cbranch_scc0 L_nowo_80
    s_mul_i32 s32, s28, 768
    s_mul_i32 s33, s74, 192
    s_add_u32 s32, s32, s33
    s_mul_i32 s33, s78, 48
    s_add_u32 s32, s32, s33
    s_mul_i32 s32, s32, 1280
    s_lshl_b32 s33, s75, 8
    s_add_u32 s32, s32, s33
    s_add_u32 s44, s12, s32
    s_addc_u32 s45, s13, 0
    s_and_b32 s45, s45, 0xffff
    s_sub_u32 s46, 0x780000, s32
    s_mov_b32 s47, 0x20000
    v_lshrrev_b32 v54, 4, v1
    v_and_b32 v55, 15, v1
    v_mul_u32_u24 v2, 1280, v54
    v_lshl_add_u32 v2, v55, 4, v2
    buffer_load_dwordx4 v[96:99], v2, s[44:47], 0 offen nt
    s_mov_b32 s35, 5120
    buffer_load_dwordx4 v[100:103], v2, s[44:47], s35 offen nt
    s_mov_b32 s35, 10240
    buffer_load_dwordx4 v[104:107], v2, s[44:47], s35 offen nt
    s_mov_b32 s35, 15360
    buffer_load_dwordx4 v[108:111], v2, s[44:47], s35 offen nt
    s_mov_b32 s35, 20480
    buffer_load_dwordx4 v[112:115], v2, s[44:47], s35 offen nt
    s_mov_b32 s35, 25600
    buffer_load_dwordx4 v[116:119], v2, s[44:47], s35 offen nt
    s_mov_b32 s35, 30720
    buffer_load_dwordx4 v[120:123], v2, s[44:47], s35 offen nt
    s_mov_b32 s35, 35840
    buffer_load_dwordx4 v[124:127], v2, s[44:47], s35 offen nt
L_nowo_80:
L_wl_79:
    s_barrier
    s_cmp_eq_u32 s31, 0
    s_cbranch_scc0 L_wl2_81
    s_barrier
    s_cmp_ge_u32 s29, 12
    s_cbranch_scc0 L_nowo_82
    s_mul_i32 s32, s28, 768
    s_mul_i32 s33, s74, 192
    s_add_u32 s32, s32, s33
    s_mul_i32 s33, s78, 48
    s_add_u32 s32, s32, s33
    s_mul_i32 s32, s32, 1280
    s_lshl_b32 s33, s75, 8
    s_add_u32 s32, s32, s33
    s_add_u32 s44, s12, s32
    s_addc_u32 s45, s13, 0
    s_and_b32 s45, s45, 0xffff
    s_sub_u32 s46, 0x780000, s32
    s_mov_b32 s47, 0x20000
    v_lshrrev_b32 v54, 4, v1
    v_and_b32 v55, 15, v1
    v_mul_u32_u24 v2, 1280, v54
    v_lshl_add_u32 v2, v55, 4, v2
    s_mov_b32 s35, 40960
    buffer_load_dwordx4 v[128:131], v2, s[44:47], s35 offen nt
    s_mov_b32 s35, 46080
    buffer_load_dwordx4 v[132:135], v2, s[44:47], s35 offen nt
    s_mov_b32 s35, 51200
    buffer_load_dwordx4 v[136:139], v2, s[44:47], s35 offen nt
    s_mov_b32 s35, 56320
    buffer_load_dwordx4 v[140:143], v2, s[44:47], s35 offen nt
L_nowo_82:
    s_cmp_lt_u32 s29, 12
    s_cbranch_scc0 L_gut_83
    v_and_b32 v52, 31, v1
    v_lshlrev_b32 v52, 10, v52
    s_lshl_b32 s32, s28, 15
    s_add_u32 s32, s32, 377856
    s_mov_b32 s34, 0x20000
L_gut_84:
    buffer_load_dword v53, v52, s[36:39], s32 offen sc1
    s_waitcnt vmcnt(0)
    v_xor_b32 v53, s94, v53
    v_cmp_ne_u32_sdwa vcc, v53, v7 src0_sel:BYTE_0 src1_sel:DWORD
    s_cbranch_vccz L_pq_85
    s_sub_u32 s34, s34, 1
    s_cbranch_scc0 L_gut_84
L_pq_85:
    s_cmp_lt_u32 s29, 15
    s_cbranch_scc0 L_nogu_86
    v_lshrrev_b32 v54, 4, v1
    v_and_b32 v55, 15, v1
    s_lshl_b32 s32, s77, 7
    s_lshl_b32 s33, s78, 5
    s_add_u32 s32, s32, s33
    s_mul_i32 s32, s32, 3072
    s_mul_i32 s33, s28, 384
    s_add_u32 s32, s32, s33
    s_lshl_b32 s33, s76, 7
    s_add_u32 s32, s32, s33
    s_add_u32 s48, s16, s32
    s_addc_u32 s49, s17, 0
    s_and_b32 s49, s49, 0xffff
    s_sub_u32 s50, 0x1e0000, s32
    s_mov_b32 s51, 0x20000
    s_add_u32 s52, s18, s32
    s_addc_u32 s53, s19, 0
    s_and_b32 s53, s53, 0xffff
    s_sub_u32 s54, 0x1e0000, s32
    s_mov_b32 s55, 0x20000
    v_mul_u32_u24 v2, 3072, v54
    v_and_b32 v56, 7, v1
    v_lshl_add_u32 v2, v56, 4, v2
    s_mov_b32 exec_lo, 0xff00ff
    s_mov_b32 exec_hi, 0xff00ff
    buffer_load_dwordx4 v[144:147], v2, s[48:51], 0 offen nt
    s_mov_b32 s35, 12288
    buffer_load_dwordx4 v[148:151], v2, s[48:51], s35 offen nt
    s_mov_b32 s35, 24576
    buffer_load_dwordx4 v[152:155], v2, s[48:51], s35 offen nt
    s_mov_b32 s35, 36864
    buffer_load_dwordx4 v[156:159], v2, s[48:51], s35 offen nt
    s_mov_b32 s35, 49152
    buffer_load_dwordx4 v[160:163], v2, s[48:51], s35 offen nt
    s_mov_b32 s35, 61440
    buffer_load_dwordx4 v[164:167], v2, s[48:51], s35 offen nt
    s_mov_b32 s35, 73728
    buffer_load_dwordx4 v[168:171], v2, s[48:51], s35 offen nt
    s_mov_b32 s35, 86016
    buffer_load_dwordx4 v[172:175], v2, s[48:51], s35 offen nt
    s_mov_b32 exec_lo, 0xff00ff00
    s_mov_b32 exec_hi, 0xff00ff00
    buffer_load_dwordx4 v[144:147], v2, s[52:55], 0 offen nt
    s_mov_b32 s35, 12288
    buffer_load_dwordx4 v[148:151], v2, s[52:55], s35 offen nt
    s_mov_b32 s35, 24576
    buffer_load_dwordx4 v[152:155], v2, s[52:55], s35 offen nt
    s_mov_b32 s35, 36864
    buffer_load_dwordx4 v[156:159], v2, s[52:55], s35 offen nt
    s_mov_b32 s35, 49152
    buffer_load_dwordx4 v[160:163], v2, s[52:55], s35 offen nt
    s_mov_b32 s35, 61440
    buffer_load_dwordx4 v[164:167], v2, s[52:55], s35 offen nt
    s_mov_b32 s35, 73728
    buffer_load_dwordx4 v[168:171], v2, s[52:55], s35 offen nt
    s_mov_b32 s35, 86016
    buffer_load_dwordx4 v[172:175], v2, s[52:55], s35 offen nt
    s_mov_b64 exec, -1
    s_mul_i32 s32, s28, 192
    s_lshl_b32 s33, s76, 6
    s_add_u32 s32, s32, s33
    s_lshl_b32 s33, s78, 4
    s_add_u32 s32, s32, s33
    s_mul_i32 s32, s32, 1280
    s_lshl_b32 s33, s77, 8
    s_add_u32 s32, s32, s33
    s_add_u32 s56, s20, s32
    s_addc_u32 s57, s21, 0
    s_and_b32 s57, s57, 0xffff
    s_sub_u32 s58, 0x1e0000, s32
    s_mov_b32 s59, 0x20000
    v_mul_u32_u24 v2, 1280, v54
    v_lshl_add_u32 v2, v55, 4, v2
    buffer_load_dwordx4 v[176:179], v2, s[56:59], 0 offen nt
    s_mov_b32 s35, 5120
    buffer_load_dwordx4 v[180:183], v2, s[56:59], s35 offen nt
    s_mov_b32 s35, 10240
    buffer_load_dwordx4 v[184:187], v2, s[56:59], s35 offen nt
    s_mov_b32 s35, 15360
    buffer_load_dwordx4 v[188:191], v2, s[56:59], s35 offen nt
L_nogu_86:
L_gut_83:
L_wl2_81:
    s_cmp_ge_u32 s29, 12
    s_cbranch_scc0 L_nowo2_87
    s_lshl_b32 s32, s28, 2
    s_add_u32 s32, s32, s74
    s_lshl_b32 s32, s32, 13
    s_mul_i32 s33, s78, 192
    s_add_u32 s32, s32, s33
    s_mul_i32 s33, s31, 262144
    s_add_u32 s32, s32, s33
    s_add_u32 s82, s32, 377088
    s_mov_b32 s34, 0x20000
    buffer_load_dwordx2 v[200:201], v14, s[36:39], s82 offen sc1
    buffer_load_dwordx4 v[192:195], v12, s[36:39], s82 offen sc1
    buffer_load_dwordx4 v[196:199], v13, s[36:39], s82 offen sc1
    s_sleep 2
L_og_88:
    buffer_load_dwordx2 v[212:213], v14, s[36:39], s82 offen sc1
    buffer_load_dwordx4 v[204:207], v12, s[36:39], s82 offen sc1
    buffer_load_dwordx4 v[208:211], v13, s[36:39], s82 offen sc1
    s_waitcnt vmcnt(3)
    v_xor_b32 v200, s94, v200
    v_xor_b32 v192, s94, v192
    v_xor_b32 v196, s94, v196
    v_or3_b32 v53, v200, v192, v196
    v_cmp_ne_u32_sdwa vcc, v53, v7 src0_sel:BYTE_0 src1_sel:DWORD
    s_cbranch_vccnz L_oga_89
    v_max_f32_dpp v52, v200, v200 row_ror:8 row_mask:0xf bank_mask:0xf
    v_mov_b32 v53, v52
    s_nop 1
    v_permlane16_swap_b32 v52, v53
    v_max_f32 v52, v52, v53
    v_mov_b32 v53, v52
    s_nop 1
    v_permlane32_swap_b32 v52, v53
    v_max_f32 v52, v52, v53
    v_sub_f32 v54, v200, v52
    v_exp_f32 v54, v54
    s_nop 0
    v_mul_f32 v52, v54, v201
    v_mul_f32 v192, v192, v54
    s_nop 0
    v_add_f32_dpp v52, v52, v52 row_ror:8 row_mask:0xf bank_mask:0xf
    v_mul_f32 v193, v193, v54
    v_mov_b32 v53, v52
    v_mul_f32 v194, v194, v54
    s_nop 0
    v_permlane16_swap_b32 v52, v53
    v_mul_f32 v195, v195, v54
    v_add_f32 v52, v52, v53
    v_mul_f32 v196, v196, v54
    v_mov_b32 v53, v52
    v_mul_f32 v197, v197, v54
    s_nop 0
    v_permlane32_swap_b32 v52, v53
    v_mul_f32 v198, v198, v54
    v_add_f32 v52, v52, v53
    v_mul_f32 v199, v199, v54
    v_rcp_f32 v52, v52
    v_permlane32_swap_b32 v192, v194
    v_permlane32_swap_b32 v193, v195
    v_permlane32_swap_b32 v196, v198
    v_permlane32_swap_b32 v197, v199
    v_add_f32 v192, v192, v194
    v_add_f32 v193, v193, v195
    v_add_f32 v196, v196, v198
    v_add_f32 v197, v197, v199
    v_permlane16_swap_b32 v192, v193
    s_nop 0
    v_permlane16_swap_b32 v196, v197
    v_add_f32 v192, v192, v193
    v_add_f32 v196, v196, v197
    s_nop 0
    v_add_f32_dpp v192, v192, v192 row_ror:8 row_mask:0xf bank_mask:0xf
    v_add_f32_dpp v196, v196, v196 row_ror:8 row_mask:0xf bank_mask:0xf
    v_mul_f32 v192, v192, v52
    v_mul_f32 v196, v196, v52
    v_cvt_pk_bf16_f32 v26, v192, v192
    v_cvt_pk_bf16_f32 v27, v196, v196
    s_branch L_ogd_91
L_oga_89:
    buffer_load_dwordx2 v[200:201], v14, s[36:39], s82 offen sc1
    buffer_load_dwordx4 v[192:195], v12, s[36:39], s82 offen sc1
    buffer_load_dwordx4 v[196:199], v13, s[36:39], s82 offen sc1
    s_waitcnt vmcnt(3)
    v_xor_b32 v212, s94, v212
    v_xor_b32 v204, s94, v204
    v_xor_b32 v208, s94, v208
    v_or3_b32 v53, v212, v204, v208
    v_cmp_ne_u32_sdwa vcc, v53, v7 src0_sel:BYTE_0 src1_sel:DWORD
    s_cbranch_vccnz L_ogb_90
    v_max_f32_dpp v52, v212, v212 row_ror:8 row_mask:0xf bank_mask:0xf
    v_mov_b32 v53, v52
    s_nop 1
    v_permlane16_swap_b32 v52, v53
    v_max_f32 v52, v52, v53
    v_mov_b32 v53, v52
    s_nop 1
    v_permlane32_swap_b32 v52, v53
    v_max_f32 v52, v52, v53
    v_sub_f32 v54, v212, v52
    v_exp_f32 v54, v54
    s_nop 0
    v_mul_f32 v52, v54, v213
    v_mul_f32 v204, v204, v54
    s_nop 0
    v_add_f32_dpp v52, v52, v52 row_ror:8 row_mask:0xf bank_mask:0xf
    v_mul_f32 v205, v205, v54
    v_mov_b32 v53, v52
    v_mul_f32 v206, v206, v54
    s_nop 0
    v_permlane16_swap_b32 v52, v53
    v_mul_f32 v207, v207, v54
    v_add_f32 v52, v52, v53
    v_mul_f32 v208, v208, v54
    v_mov_b32 v53, v52
    v_mul_f32 v209, v209, v54
    s_nop 0
    v_permlane32_swap_b32 v52, v53
    v_mul_f32 v210, v210, v54
    v_add_f32 v52, v52, v53
    v_mul_f32 v211, v211, v54
    v_rcp_f32 v52, v52
    v_permlane32_swap_b32 v204, v206
    v_permlane32_swap_b32 v205, v207
    v_permlane32_swap_b32 v208, v210
    v_permlane32_swap_b32 v209, v211
    v_add_f32 v204, v204, v206
    v_add_f32 v205, v205, v207
    v_add_f32 v208, v208, v210
    v_add_f32 v209, v209, v211
    v_permlane16_swap_b32 v204, v205
    s_nop 0
    v_permlane16_swap_b32 v208, v209
    v_add_f32 v204, v204, v205
    v_add_f32 v208, v208, v209
    s_nop 0
    v_add_f32_dpp v204, v204, v204 row_ror:8 row_mask:0xf bank_mask:0xf
    v_add_f32_dpp v208, v208, v208 row_ror:8 row_mask:0xf bank_mask:0xf
    v_mul_f32 v204, v204, v52
    v_mul_f32 v208, v208, v52
    v_cvt_pk_bf16_f32 v26, v204, v204
    v_cvt_pk_bf16_f32 v27, v208, v208
    s_branch L_ogd_91
L_ogb_90:
    s_sub_u32 s34, s34, 1
    s_cbranch_scc0 L_og_88
L_ogd_91:
    v_and_b32_dpp v32, v26, v8 row_newbcast:0 row_mask:0xf bank_mask:0xf
    v_and_b32_dpp v33, v26, v9 row_newbcast:0 row_mask:0xf bank_mask:0xf
    v_and_b32_dpp v34, v26, v10 row_newbcast:0 row_mask:0xf bank_mask:0xf
    v_and_b32_dpp v35, v26, v11 row_newbcast:0 row_mask:0xf bank_mask:0xf
    v_and_b32_dpp v36, v26, v8 row_newbcast:1 row_mask:0xf bank_mask:0xf
    v_and_b32_dpp v37, v26, v9 row_newbcast:1 row_mask:0xf bank_mask:0xf
    v_and_b32_dpp v38, v26, v10 row_newbcast:1 row_mask:0xf bank_mask:0xf
    v_and_b32_dpp v39, v26, v11 row_newbcast:1 row_mask:0xf bank_mask:0xf
    v_mfma_f32_16x16x32_bf16 v[40:43], v[32:35], v[96:99], 0
    v_and_b32_dpp v32, v26, v8 row_newbcast:2 row_mask:0xf bank_mask:0xf
    v_and_b32_dpp v33, v26, v9 row_newbcast:2 row_mask:0xf bank_mask:0xf
    v_and_b32_dpp v34, v26, v10 row_newbcast:2 row_mask:0xf bank_mask:0xf
    v_and_b32_dpp v35, v26, v11 row_newbcast:2 row_mask:0xf bank_mask:0xf
    v_mfma_f32_16x16x32_bf16 v[40:43], v[36:39], v[100:103], v[40:43]
    v_and_b32_dpp v36, v26, v8 row_newbcast:3 row_mask:0xf bank_mask:0xf
    v_and_b32_dpp v37, v26, v9 row_newbcast:3 row_mask:0xf bank_mask:0xf
    v_and_b32_dpp v38, v26, v10 row_newbcast:3 row_mask:0xf bank_mask:0xf
    v_and_b32_dpp v39, v26, v11 row_newbcast:3 row_mask:0xf bank_mask:0xf
    v_mfma_f32_16x16x32_bf16 v[40:43], v[32:35], v[104:107], v[40:43]
    v_and_b32_dpp v32, v26, v8 row_newbcast:4 row_mask:0xf bank_mask:0xf
    v_and_b32_dpp v33, v26, v9 row_newbcast:4 row_mask:0xf bank_mask:0xf
    v_and_b32_dpp v34, v26, v10 row_newbcast:4 row_mask:0xf bank_mask:0xf
    v_and_b32_dpp v35, v26, v11 row_newbcast:4 row_mask:0xf bank_mask:0xf
    v_mfma_f32_16x16x32_bf16 v[40:43], v[36:39], v[108:111], v[40:43]
    v_and_b32_dpp v36, v26, v8 row_newbcast:5 row_mask:0xf bank_mask:0xf
    v_and_b32_dpp v37, v26, v9 row_newbcast:5 row_mask:0xf bank_mask:0xf
    v_and_b32_dpp v38, v26, v10 row_newbcast:5 row_mask:0xf bank_mask:0xf
    v_and_b32_dpp v39, v26, v11 row_newbcast:5 row_mask:0xf bank_mask:0xf
    v_mfma_f32_16x16x32_bf16 v[40:43], v[32:35], v[112:115], v[40:43]
    v_and_b32_dpp v32, v26, v8 row_newbcast:6 row_mask:0xf bank_mask:0xf
    v_and_b32_dpp v33, v26, v9 row_newbcast:6 row_mask:0xf bank_mask:0xf
    v_and_b32_dpp v34, v26, v10 row_newbcast:6 row_mask:0xf bank_mask:0xf
    v_and_b32_dpp v35, v26, v11 row_newbcast:6 row_mask:0xf bank_mask:0xf
    v_mfma_f32_16x16x32_bf16 v[40:43], v[36:39], v[116:119], v[40:43]
    v_and_b32_dpp v36, v26, v8 row_newbcast:7 row_mask:0xf bank_mask:0xf
    v_and_b32_dpp v37, v26, v9 row_newbcast:7 row_mask:0xf bank_mask:0xf
    v_and_b32_dpp v38, v26, v10 row_newbcast:7 row_mask:0xf bank_mask:0xf
    v_and_b32_dpp v39, v26, v11 row_newbcast:7 row_mask:0xf bank_mask:0xf
    v_mfma_f32_16x16x32_bf16 v[40:43], v[32:35], v[120:123], v[40:43]
    v_and_b32_dpp v32, v27, v8 row_newbcast:0 row_mask:0xf bank_mask:0xf
    v_and_b32_dpp v33, v27, v9 row_newbcast:0 row_mask:0xf bank_mask:0xf
    v_and_b32_dpp v34, v27, v10 row_newbcast:0 row_mask:0xf bank_mask:0xf
    v_and_b32_dpp v35, v27, v11 row_newbcast:0 row_mask:0xf bank_mask:0xf
    v_mfma_f32_16x16x32_bf16 v[40:43], v[36:39], v[124:127], v[40:43]
    v_and_b32_dpp v36, v27, v8 row_newbcast:1 row_mask:0xf bank_mask:0xf
    v_and_b32_dpp v37, v27, v9 row_newbcast:1 row_mask:0xf bank_mask:0xf
    v_and_b32_dpp v38, v27, v10 row_newbcast:1 row_mask:0xf bank_mask:0xf
    v_and_b32_dpp v39, v27, v11 row_newbcast:1 row_mask:0xf bank_mask:0xf
    v_mfma_f32_16x16x32_bf16 v[40:43], v[32:35], v[128:131], v[40:43]
    v_and_b32_dpp v32, v27, v8 row_newbcast:2 row_mask:0xf bank_mask:0xf
    v_and_b32_dpp v33, v27, v9 row_newbcast:2 row_mask:0xf bank_mask:0xf
    v_and_b32_dpp v34, v27, v10 row_newbcast:2 row_mask:0xf bank_mask:0xf
    v_and_b32_dpp v35, v27, v11 row_newbcast:2 row_mask:0xf bank_mask:0xf
    v_mfma_f32_16x16x32_bf16 v[40:43], v[36:39], v[132:135], v[40:43]
    v_and_b32_dpp v36, v27, v8 row_newbcast:3 row_mask:0xf bank_mask:0xf
    v_and_b32_dpp v37, v27, v9 row_newbcast:3 row_mask:0xf bank_mask:0xf
    v_and_b32_dpp v38, v27, v10 row_newbcast:3 row_mask:0xf bank_mask:0xf
    v_and_b32_dpp v39, v27, v11 row_newbcast:3 row_mask:0xf bank_mask:0xf
    v_mfma_f32_16x16x32_bf16 v[40:43], v[32:35], v[136:139], v[40:43]
    s_nop 0
    v_mfma_f32_16x16x32_bf16 v[40:43], v[36:39], v[140:143], v[40:43]
    s_nop 7
    ds_write_b128 v6, v[40:43] offset:8704
    s_branch L_e1_92
L_nowo2_87:
L_e1_92:
    s_waitcnt lgkmcnt(0)
    s_barrier
    s_cmp_eq_u32 s31, 0
    s_cbranch_scc0 L_gut2_93
    s_cmp_ge_u32 s29, 12
    s_cbranch_scc0 L_gut2_93
    s_cmp_lt_u32 s29, 15
    s_cbranch_scc0 L_nogu_94
    v_lshrrev_b32 v54, 4, v1
    v_and_b32 v55, 15, v1
    s_lshl_b32 s32, s77, 7
    s_lshl_b32 s33, s78, 5
    s_add_u32 s32, s32, s33
    s_mul_i32 s32, s32, 3072
    s_mul_i32 s33, s28, 384
    s_add_u32 s32, s32, s33
    s_lshl_b32 s33, s76, 7
    s_add_u32 s32, s32, s33
    s_add_u32 s48, s16, s32
    s_addc_u32 s49, s17, 0
    s_and_b32 s49, s49, 0xffff
    s_sub_u32 s50, 0x1e0000, s32
    s_mov_b32 s51, 0x20000
    s_add_u32 s52, s18, s32
    s_addc_u32 s53, s19, 0
    s_and_b32 s53, s53, 0xffff
    s_sub_u32 s54, 0x1e0000, s32
    s_mov_b32 s55, 0x20000
    v_mul_u32_u24 v2, 3072, v54
    v_and_b32 v56, 7, v1
    v_lshl_add_u32 v2, v56, 4, v2
    s_mov_b32 exec_lo, 0xff00ff
    s_mov_b32 exec_hi, 0xff00ff
    buffer_load_dwordx4 v[144:147], v2, s[48:51], 0 offen nt
    s_mov_b32 s35, 12288
    buffer_load_dwordx4 v[148:151], v2, s[48:51], s35 offen nt
    s_mov_b32 s35, 24576
    buffer_load_dwordx4 v[152:155], v2, s[48:51], s35 offen nt
    s_mov_b32 s35, 36864
    buffer_load_dwordx4 v[156:159], v2, s[48:51], s35 offen nt
    s_mov_b32 s35, 49152
    buffer_load_dwordx4 v[160:163], v2, s[48:51], s35 offen nt
    s_mov_b32 s35, 61440
    buffer_load_dwordx4 v[164:167], v2, s[48:51], s35 offen nt
    s_mov_b32 s35, 73728
    buffer_load_dwordx4 v[168:171], v2, s[48:51], s35 offen nt
    s_mov_b32 s35, 86016
    buffer_load_dwordx4 v[172:175], v2, s[48:51], s35 offen nt
    s_mov_b32 exec_lo, 0xff00ff00
    s_mov_b32 exec_hi, 0xff00ff00
    buffer_load_dwordx4 v[144:147], v2, s[52:55], 0 offen nt
    s_mov_b32 s35, 12288
    buffer_load_dwordx4 v[148:151], v2, s[52:55], s35 offen nt
    s_mov_b32 s35, 24576
    buffer_load_dwordx4 v[152:155], v2, s[52:55], s35 offen nt
    s_mov_b32 s35, 36864
    buffer_load_dwordx4 v[156:159], v2, s[52:55], s35 offen nt
    s_mov_b32 s35, 49152
    buffer_load_dwordx4 v[160:163], v2, s[52:55], s35 offen nt
    s_mov_b32 s35, 61440
    buffer_load_dwordx4 v[164:167], v2, s[52:55], s35 offen nt
    s_mov_b32 s35, 73728
    buffer_load_dwordx4 v[168:171], v2, s[52:55], s35 offen nt
    s_mov_b32 s35, 86016
    buffer_load_dwordx4 v[172:175], v2, s[52:55], s35 offen nt
    s_mov_b64 exec, -1
    s_mul_i32 s32, s28, 192
    s_lshl_b32 s33, s76, 6
    s_add_u32 s32, s32, s33
    s_lshl_b32 s33, s78, 4
    s_add_u32 s32, s32, s33
    s_mul_i32 s32, s32, 1280
    s_lshl_b32 s33, s77, 8
    s_add_u32 s32, s32, s33
    s_add_u32 s56, s20, s32
    s_addc_u32 s57, s21, 0
    s_and_b32 s57, s57, 0xffff
    s_sub_u32 s58, 0x1e0000, s32
    s_mov_b32 s59, 0x20000
    v_mul_u32_u24 v2, 1280, v54
    v_lshl_add_u32 v2, v55, 4, v2
    buffer_load_dwordx4 v[176:179], v2, s[56:59], 0 offen nt
    s_mov_b32 s35, 5120
    buffer_load_dwordx4 v[180:183], v2, s[56:59], s35 offen nt
    s_mov_b32 s35, 10240
    buffer_load_dwordx4 v[184:187], v2, s[56:59], s35 offen nt
    s_mov_b32 s35, 15360
    buffer_load_dwordx4 v[188:191], v2, s[56:59], s35 offen nt
L_nogu_94:
L_gut2_93:
    s_cmp_lt_u32 s29, 15
    s_cbranch_scc0 L_nogu2_95
    s_add_u32 s92, s77, 12
    s_lshl_b32 s32, s77, 9
    s_lshl_b32 s33, s78, 7
    s_add_u32 s32, s32, s33
    s_add_u32 s82, s86, s32
    s_add_u32 s83, s87, s32
    s_add_u32 s80, s82, 20480
    s_add_u32 s81, s82, 40960
    s_add_u32 s33, s82, 61440
    s_cmp_eq_u32 s79, 1
    s_cbranch_scc0 L_hw_96
    s_lshl_b32 s32, s92, 2
    s_add_u32 s32, s32, s88
    s_mov_b32 s34, 0x20000
    buffer_load_dword v244, v240, s[36:39], s32 offen sc1
    s_sleep 2
L_hw_97:
    buffer_load_dword v245, v240, s[36:39], s32 offen sc1
    s_waitcnt vmcnt(1)
    v_cmp_ne_u32 vcc, s93, v244
    s_cbranch_vccnz L_hwa_98
    s_branch L_hwd_100
L_hwa_98:
    buffer_load_dword v244, v240, s[36:39], s32 offen sc1
    s_waitcnt vmcnt(1)
    v_cmp_ne_u32 vcc, s93, v245
    s_cbranch_vccnz L_hwb_99
    s_branch L_hwd_100
L_hwb_99:
    s_sub_u32 s34, s34, 1
    s_cbranch_scc0 L_hw_97
L_hwd_100:
L_hw_96:
    s_mov_b32 s34, 0x20000
    buffer_load_dwordx4 v[192:195], v3, s[36:39], s82 offen sc1
    buffer_load_dwordx4 v[196:199], v3, s[36:39], s80 offen sc1
    buffer_load_dwordx4 v[200:203], v3, s[36:39], s81 offen sc1
    buffer_load_dwordx4 v[204:207], v3, s[36:39], s33 offen sc1
    buffer_load_dword v208, v4, s[36:39], s83 offen sc1
    s_sleep 5
L_xg_101:
    buffer_load_dwordx4 v[212:215], v3, s[36:39], s82 offen sc1
    buffer_load_dwordx4 v[216:219], v3, s[36:39], s80 offen sc1
    buffer_load_dwordx4 v[220:223], v3, s[36:39], s81 offen sc1
    buffer_load_dwordx4 v[224:227], v3, s[36:39], s33 offen sc1
    buffer_load_dword v228, v4, s[36:39], s83 offen sc1
    s_waitcnt vmcnt(5)
    v_xor_b32 v192, s94, v192
    v_xor_b32 v196, s94, v196
    v_xor_b32 v200, s94, v200
    v_xor_b32 v204, s94, v204
    v_xor_b32 v208, s95, v208
    v_or3_b32 v209, v192, v196, v200
    v_or_b32 v209, v209, v204
    v_and_b32 v209, 0xff, v209
    v_and_or_b32 v209, v208, v63, v209
    v_cmp_ne_u32 vcc, 0, v209
    s_cbranch_vccnz L_xga_102
    v_pk_add_f32 v[192:193], v[192:193], v[196:197]
    v_pk_add_f32 v[200:201], v[200:201], v[204:205]
    v_pk_add_f32 v[194:195], v[194:195], v[198:199]
    v_pk_add_f32 v[202:203], v[202:203], v[206:207]
    v_pk_add_f32 v[192:193], v[192:193], v[200:201]
    v_pk_add_f32 v[194:195], v[194:195], v[202:203]
    s_nop 1
    v_permlane32_swap_b32 v192, v194
    v_permlane32_swap_b32 v193, v195
    v_add_f32 v192, v192, v194
    v_add_f32 v193, v193, v195
    s_nop 1
    v_permlane16_swap_b32 v192, v193
    v_add_f32 v192, v192, v193
    s_nop 1
    v_add_f32_dpp v192, v192, v192 row_ror:8 row_mask:0xf bank_mask:0xf
    v_add_f32 v29, v192, v208
    s_branch L_xgd_104
L_xga_102:
    buffer_load_dwordx4 v[192:195], v3, s[36:39], s82 offen sc1
    buffer_load_dwordx4 v[196:199], v3, s[36:39], s80 offen sc1
    buffer_load_dwordx4 v[200:203], v3, s[36:39], s81 offen sc1
    buffer_load_dwordx4 v[204:207], v3, s[36:39], s33 offen sc1
    buffer_load_dword v208, v4, s[36:39], s83 offen sc1
    s_waitcnt vmcnt(5)
    v_xor_b32 v212, s94, v212
    v_xor_b32 v216, s94, v216
    v_xor_b32 v220, s94, v220
    v_xor_b32 v224, s94, v224
    v_xor_b32 v228, s95, v228
    v_or3_b32 v229, v212, v216, v220
    v_or_b32 v229, v229, v224
    v_and_b32 v229, 0xff, v229
    v_and_or_b32 v229, v228, v63, v229
    v_cmp_ne_u32 vcc, 0, v229
    s_cbranch_vccnz L_xgb_103
    v_pk_add_f32 v[212:213], v[212:213], v[216:217]
    v_pk_add_f32 v[220:221], v[220:221], v[224:225]
    v_pk_add_f32 v[214:215], v[214:215], v[218:219]
    v_pk_add_f32 v[222:223], v[222:223], v[226:227]
    v_pk_add_f32 v[212:213], v[212:213], v[220:221]
    v_pk_add_f32 v[214:215], v[214:215], v[222:223]
    s_nop 1
    v_permlane32_swap_b32 v212, v214
    v_permlane32_swap_b32 v213, v215
    v_add_f32 v212, v212, v214
    v_add_f32 v213, v213, v215
    s_nop 1
    v_permlane16_swap_b32 v212, v213
    v_add_f32 v212, v212, v213
    s_nop 1
    v_add_f32_dpp v212, v212, v212 row_ror:8 row_mask:0xf bank_mask:0xf
    v_add_f32 v29, v212, v228
    s_branch L_xgd_104
L_xgb_103:
    s_sub_u32 s34, s34, 1
    s_cbranch_scc0 L_xg_101
L_xgd_104:
    v_cvt_pk_bf16_f32 v26, v29, v29
    v_and_b32 v25, 0xffff0000, v26
    s_nop 0
    v_and_b32_dpp v32, v26, v8 row_newbcast:0 row_mask:0xf bank_mask:0xf
    v_and_b32_dpp v33, v26, v9 row_newbcast:0 row_mask:0xf bank_mask:0xf
    v_and_b32_dpp v34, v26, v10 row_newbcast:0 row_mask:0xf bank_mask:0xf
    v_and_b32_dpp v35, v26, v11 row_newbcast:0 row_mask:0xf bank_mask:0xf
    v_and_b32_dpp v36, v26, v8 row_newbcast:1 row_mask:0xf bank_mask:0xf
    v_and_b32_dpp v37, v26, v9 row_newbcast:1 row_mask:0xf bank_mask:0xf
    v_and_b32_dpp v38, v26, v10 row_newbcast:1 row_mask:0xf bank_mask:0xf
    v_and_b32_dpp v39, v26, v11 row_newbcast:1 row_mask:0xf bank_mask:0xf
    v_mfma_f32_16x16x32_bf16 v[40:43], v[32:35], v[144:147], 0
    v_mul_f32 v31, v25, v25
    v_and_b32_dpp v32, v26, v8 row_newbcast:2 row_mask:0xf bank_mask:0xf
    v_and_b32_dpp v33, v26, v9 row_newbcast:2 row_mask:0xf bank_mask:0xf
    v_and_b32_dpp v34, v26, v10 row_newbcast:2 row_mask:0xf bank_mask:0xf
    v_and_b32_dpp v35, v26, v11 row_newbcast:2 row_mask:0xf bank_mask:0xf
    v_mfma_f32_16x16x32_bf16 v[40:43], v[36:39], v[148:151], v[40:43]
    v_cndmask_b32 v30, v25, v31, s[68:69]
    v_and_b32_dpp v36, v26, v8 row_newbcast:3 row_mask:0xf bank_mask:0xf
    v_and_b32_dpp v37, v26, v9 row_newbcast:3 row_mask:0xf bank_mask:0xf
    v_and_b32_dpp v38, v26, v10 row_newbcast:3 row_mask:0xf bank_mask:0xf
    v_and_b32_dpp v39, v26, v11 row_newbcast:3 row_mask:0xf bank_mask:0xf
    v_mfma_f32_16x16x32_bf16 v[40:43], v[32:35], v[152:155], v[40:43]
    v_add_f32_dpp v30, v30, v30 quad_perm:[1,0,3,2] row_mask:0xf bank_mask:0xf
    v_and_b32_dpp v32, v26, v8 row_newbcast:4 row_mask:0xf bank_mask:0xf
    v_and_b32_dpp v33, v26, v9 row_newbcast:4 row_mask:0xf bank_mask:0xf
    v_and_b32_dpp v34, v26, v10 row_newbcast:4 row_mask:0xf bank_mask:0xf
    v_and_b32_dpp v35, v26, v11 row_newbcast:4 row_mask:0xf bank_mask:0xf
    v_mfma_f32_16x16x32_bf16 v[40:43], v[36:39], v[156:159], v[40:43]
    v_add_f32_dpp v30, v30, v30 quad_perm:[2,3,0,1] row_mask:0xf bank_mask:0xf
    v_and_b32_dpp v36, v26, v8 row_newbcast:5 row_mask:0xf bank_mask:0xf
    v_and_b32_dpp v37, v26, v9 row_newbcast:5 row_mask:0xf bank_mask:0xf
    v_and_b32_dpp v38, v26, v10 row_newbcast:5 row_mask:0xf bank_mask:0xf
    v_and_b32_dpp v39, v26, v11 row_newbcast:5 row_mask:0xf bank_mask:0xf
    v_mfma_f32_16x16x32_bf16 v[40:43], v[32:35], v[160:163], v[40:43]
    v_add_f32_dpp v30, v30, v30 row_half_mirror row_mask:0xf bank_mask:0xf
    v_and_b32_dpp v32, v26, v8 row_newbcast:6 row_mask:0xf bank_mask:0xf
    v_and_b32_dpp v33, v26, v9 row_newbcast:6 row_mask:0xf bank_mask:0xf
    v_and_b32_dpp v34, v26, v10 row_newbcast:6 row_mask:0xf bank_mask:0xf
    v_and_b32_dpp v35, v26, v11 row_newbcast:6 row_mask:0xf bank_mask:0xf
    v_mfma_f32_16x16x32_bf16 v[40:43], v[36:39], v[164:167], v[40:43]
    v_mov_b32 v31, v30
    v_and_b32_dpp v36, v26, v8 row_newbcast:7 row_mask:0xf bank_mask:0xf
    v_and_b32_dpp v37, v26, v9 row_newbcast:7 row_mask:0xf bank_mask:0xf
    v_and_b32_dpp v38, v26, v10 row_newbcast:7 row_mask:0xf bank_mask:0xf
    v_and_b32_dpp v39, v26, v11 row_newbcast:7 row_mask:0xf bank_mask:0xf
    v_mfma_f32_16x16x32_bf16 v[40:43], v[32:35], v[168:171], v[40:43]
    v_permlane16_swap_b32 v30, v31
    v_mfma_f32_16x16x32_bf16 v[40:43], v[36:39], v[172:175], v[40:43]
    v_add_f32 v30, v30, v31
    v_mov_b32 v31, v30
    s_nop 1
    v_permlane32_swap_b32 v30, v31
    v_add_f32 v30, v30, v31
    s_cmp_eq_u32 s31, 0
    s_cbranch_scc0 L_nos_105
    v_and_b32 v48, 0x3f803f80, v8
    v_and_b32 v49, 0x3f803f80, v9
    v_and_b32 v50, 0x3f803f80, v10
    v_and_b32 v51, 0x3f803f80, v11
    s_nop 1
    v_mfma_f32_16x16x32_bf16 v[44:47], v[48:51], v[144:147], 0
    v_mfma_f32_16x16x32_bf16 v[44:47], v[48:51], v[148:151], v[44:47]
    v_mfma_f32_16x16x32_bf16 v[44:47], v[48:51], v[152:155], v[44:47]
    v_mfma_f32_16x16x32_bf16 v[44:47], v[48:51], v[156:159], v[44:47]
    v_mfma_f32_16x16x32_bf16 v[44:47], v[48:51], v[160:163], v[44:47]
    v_mfma_f32_16x16x32_bf16 v[44:47], v[48:51], v[164:167], v[44:47]
    v_mfma_f32_16x16x32_bf16 v[44:47], v[48:51], v[168:171], v[44:47]
    v_mfma_f32_16x16x32_bf16 v[44:47], v[48:51], v[172:175], v[44:47]
    s_mov_b32 exec_lo, 0x0
    s_mov_b32 exec_hi, 0xffffffff
    s_nop 5
    v_mov_b32 v40, v44
    v_mov_b32 v41, v45
    v_mov_b32 v42, v46
    v_mov_b32 v43, v47
    s_mov_b64 exec, -1
L_nos_105:
    ds_write_b128 v6, v[40:43] offset:13056
    s_mov_b32 exec_lo, 0x101
    s_mov_b32 exec_hi, 0x0
    ds_write_b32 v5, v30 offset:17152
    s_mov_b64 exec, -1
    s_cmp_eq_u32 s28, 0
    s_cbranch_scc0 L_xr2_106
    s_cmp_eq_u32 s76, 0
    s_cbranch_scc0 L_xr2_106
    s_lshl_b32 s32, s77, 9
    s_lshl_b32 s33, s78, 7
    s_add_u32 s32, s32, s33
    s_add_u32 s32, s32, s85
    s_add_u32 s32, s32, 2560
    v_or_b32 v57, s95, v25
    s_mov_b32 exec_lo, 0xff00ff
    s_mov_b32 exec_hi, 0xff00ff
    buffer_store_dword v57, v4, s[36:39], s32 offen sc1
    s_mov_b64 exec, -1
L_xr2_106:
    s_branch L_e2_107
L_nogu2_95:
L_e2_107:
    s_waitcnt lgkmcnt(0)
    s_barrier
    s_cmp_lt_u32 s29, 15
    s_cbranch_scc0 L_nodn_108
    s_mul_i32 s32, s28, 3
    s_add_u32 s32, s32, s76
    s_mul_i32 s82, s32, 2560
    s_lshl_b32 s33, s78, 6
    s_add_u32 s82, s82, s33
    s_mul_i32 s33, s31, 24
    s_add_u32 s32, s32, s33
    s_lshl_b32 s32, s32, 7
    s_add_u32 s83, s32, 1249536
    s_add_u32 s80, s82, 1188096
    s_mul_i32 s32, s31, 61440
    s_add_u32 s82, s82, s32
    s_add_u32 s82, s82, 1065216
    s_mov_b32 s34, 0x20000
    buffer_load_dwordx4 v[196:199], v242, s[36:39], s83 offen sc1
    buffer_load_dwordx4 v[200:203], v15, s[36:39], s80 offen sc1
    buffer_load_dwordx4 v[192:195], v15, s[36:39], s82 offen sc1
    s_sleep 2
L_hg_109:
    buffer_load_dwordx4 v[208:211], v242, s[36:39], s83 offen sc1
    buffer_load_dwordx4 v[212:215], v15, s[36:39], s80 offen sc1
    buffer_load_dwordx4 v[204:207], v15, s[36:39], s82 offen sc1
    s_waitcnt vmcnt(3)
    v_xor_b32 v192, v28, v192
    v_xor_b32 v200, v28, v200
    v_xor_b32 v198, v243, v198
    v_or_b32 v59, v192, v200
    v_and_or_b32 v59, v59, v62, v198
    v_cmp_ne_u32 vcc, 0, v59
    s_cbranch_vccnz L_hga_110
    v_add_f32_dpp v196, v196, v196 row_ror:1 row_mask:0xf bank_mask:0xf
    v_permlane32_swap_b32 v192, v194
    v_permlane32_swap_b32 v200, v202
    v_add_f32_dpp v197, v197, v197 row_ror:1 row_mask:0xf bank_mask:0xf
    v_permlane32_swap_b32 v193, v195
    v_permlane32_swap_b32 v201, v203
    v_add_f32_dpp v196, v196, v196 row_ror:2 row_mask:0xf bank_mask:0xf
    v_add_f32 v192, v192, v194
    v_add_f32 v200, v200, v202
    v_add_f32_dpp v197, v197, v197 row_ror:2 row_mask:0xf bank_mask:0xf
    v_add_f32 v193, v193, v195
    v_add_f32 v201, v201, v203
    v_add_f32_dpp v196, v196, v196 row_ror:4 row_mask:0xf bank_mask:0xf
    v_permlane16_swap_b32 v192, v193
    v_permlane16_swap_b32 v200, v201
    v_add_f32_dpp v197, v197, v197 row_ror:4 row_mask:0xf bank_mask:0xf
    v_add_f32 v192, v192, v193
    v_add_f32 v200, v200, v201
    v_add_f32_dpp v196, v196, v196 row_ror:8 row_mask:0xf bank_mask:0xf
    v_add_f32_dpp v192, v192, v192 row_ror:8 row_mask:0xf bank_mask:0xf
    v_add_f32_dpp v200, v200, v200 row_ror:8 row_mask:0xf bank_mask:0xf
    v_add_f32_dpp v197, v197, v197 row_ror:8 row_mask:0xf bank_mask:0xf
    v_mul_f32 v196, 0x3acccccd, v196
    v_mul_f32 v197, 0x3acccccd, v197
    v_fma_f32 v197, -v196, v196, v197
    v_add_f32 v197, 0x3727c5ac, v197
    v_rsq_f32 v197, v197
    v_fma_f32 v192, -v196, v200, v192
    v_mul_f32 v192, v192, v197
    s_nop 1
    v_mul_f32_dpp v193, v192, v192 row_ror:4 row_mask:0xf bank_mask:0xf
    v_cvt_pk_bf16_f32 v26, v193, v193
    s_branch L_hgd_112
L_hga_110:
    buffer_load_dwordx4 v[196:199], v242, s[36:39], s83 offen sc1
    buffer_load_dwordx4 v[200:203], v15, s[36:39], s80 offen sc1
    buffer_load_dwordx4 v[192:195], v15, s[36:39], s82 offen sc1
    s_waitcnt vmcnt(3)
    v_xor_b32 v204, v28, v204
    v_xor_b32 v212, v28, v212
    v_xor_b32 v210, v243, v210
    v_or_b32 v59, v204, v212
    v_and_or_b32 v59, v59, v62, v210
    v_cmp_ne_u32 vcc, 0, v59
    s_cbranch_vccnz L_hgb_111
    v_add_f32_dpp v208, v208, v208 row_ror:1 row_mask:0xf bank_mask:0xf
    v_permlane32_swap_b32 v204, v206
    v_permlane32_swap_b32 v212, v214
    v_add_f32_dpp v209, v209, v209 row_ror:1 row_mask:0xf bank_mask:0xf
    v_permlane32_swap_b32 v205, v207
    v_permlane32_swap_b32 v213, v215
    v_add_f32_dpp v208, v208, v208 row_ror:2 row_mask:0xf bank_mask:0xf
    v_add_f32 v204, v204, v206
    v_add_f32 v212, v212, v214
    v_add_f32_dpp v209, v209, v209 row_ror:2 row_mask:0xf bank_mask:0xf
    v_add_f32 v205, v205, v207
    v_add_f32 v213, v213, v215
    v_add_f32_dpp v208, v208, v208 row_ror:4 row_mask:0xf bank_mask:0xf
    v_permlane16_swap_b32 v204, v205
    v_permlane16_swap_b32 v212, v213
    v_add_f32_dpp v209, v209, v209 row_ror:4 row_mask:0xf bank_mask:0xf
    v_add_f32 v204, v204, v205
    v_add_f32 v212, v212, v213
    v_add_f32_dpp v208, v208, v208 row_ror:8 row_mask:0xf bank_mask:0xf
    v_add_f32_dpp v204, v204, v204 row_ror:8 row_mask:0xf bank_mask:0xf
    v_add_f32_dpp v212, v212, v212 row_ror:8 row_mask:0xf bank_mask:0xf
    v_add_f32_dpp v209, v209, v209 row_ror:8 row_mask:0xf bank_mask:0xf
    v_mul_f32 v208, 0x3acccccd, v208
    v_mul_f32 v209, 0x3acccccd, v209
    v_fma_f32 v209, -v208, v208, v209
    v_add_f32 v209, 0x3727c5ac, v209
    v_rsq_f32 v209, v209
    v_fma_f32 v204, -v208, v212, v204
    v_mul_f32 v204, v204, v209
    s_nop 1
    v_mul_f32_dpp v205, v204, v204 row_ror:4 row_mask:0xf bank_mask:0xf
    v_cvt_pk_bf16_f32 v26, v205, v205
    s_branch L_hgd_112
L_hgb_111:
    s_sub_u32 s34, s34, 1
    s_cbranch_scc0 L_hg_109
L_hgd_112:
    s_nop 0
    v_and_b32_dpp v32, v26, v8 row_newbcast:0 row_mask:0xf bank_mask:0xf
    v_and_b32_dpp v33, v26, v9 row_newbcast:0 row_mask:0xf bank_mask:0xf
    v_and_b32_dpp v34, v26, v10 row_newbcast:0 row_mask:0xf bank_mask:0xf
    v_and_b32_dpp v35, v26, v11 row_newbcast:0 row_mask:0xf bank_mask:0xf
    v_and_b32_dpp v36, v26, v8 row_newbcast:1 row_mask:0xf bank_mask:0xf
    v_and_b32_dpp v37, v26, v9 row_newbcast:1 row_mask:0xf bank_mask:0xf
    v_and_b32_dpp v38, v26, v10 row_newbcast:1 row_mask:0xf bank_mask:0xf
    v_and_b32_dpp v39, v26, v11 row_newbcast:1 row_mask:0xf bank_mask:0xf
    v_mfma_f32_16x16x32_bf16 v[40:43], v[32:35], v[176:179], 0
    v_and_b32_dpp v32, v26, v8 row_newbcast:2 row_mask:0xf bank_mask:0xf
    v_and_b32_dpp v33, v26, v9 row_newbcast:2 row_mask:0xf bank_mask:0xf
    v_and_b32_dpp v34, v26, v10 row_newbcast:2 row_mask:0xf bank_mask:0xf
    v_and_b32_dpp v35, v26, v11 row_newbcast:2 row_mask:0xf bank_mask:0xf
    v_mfma_f32_16x16x32_bf16 v[40:43], v[36:39], v[180:183], v[40:43]
    v_and_b32_dpp v36, v26, v8 row_newbcast:3 row_mask:0xf bank_mask:0xf
    v_and_b32_dpp v37, v26, v9 row_newbcast:3 row_mask:0xf bank_mask:0xf
    v_and_b32_dpp v38, v26, v10 row_newbcast:3 row_mask:0xf bank_mask:0xf
    v_and_b32_dpp v39, v26, v11 row_newbcast:3 row_mask:0xf bank_mask:0xf
    v_mfma_f32_16x16x32_bf16 v[40:43], v[32:35], v[184:187], v[40:43]
    s_nop 0
    v_mfma_f32_16x16x32_bf16 v[40:43], v[36:39], v[188:191], v[40:43]
    s_nop 7
    ds_write_b128 v6, v[40:43] offset:17408
    s_branch L_e3_113
L_nodn_108:
L_e3_113:
    s_waitcnt lgkmcnt(0)
    s_barrier
    s_add_u32 s31, s31, 1
    s_add_u32 s84, s84, 61440
    s_add_u32 s85, s85, 2560
    s_add_u32 s86, s86, 81920
    s_add_u32 s87, s87, 2560
    s_add_u32 s88, s88, 1024
    s_add_u32 s89, s89, 1024
    s_add_u32 s90, s90, 122880
    s_add_u32 s91, s91, 1024
    s_cmp_lt_u32 s31, 2
    s_cbranch_scc1 L_W_LOOP
    s_cmp_eq_u32 s28, 0
    s_cbranch_scc0 L_fin_114
    s_cmp_eq_u32 s73, 0
    s_cbranch_scc0 L_fin_114
    s_cmp_ge_u32 s29, 2
    s_cbranch_scc0 L_fin_114
    s_branch L_W_LOOP
L_FINAL:
    s_mov_b32 s64, s22
    s_and_b32 s65, s23, 0xffff
    s_mov_b32 s66, 0x500
    s_mov_b32 s67, 0x20000
    v_cvt_pk_bf16_f32 v26, v29, v29
    s_lshl_b32 s32, s72, 8
    s_lshl_b32 s33, s78, 6
    s_add_u32 s32, s32, s33
    v_lshrrev_b32 v52, 1, v4
    s_mov_b32 exec_lo, 0xff00ff
    s_mov_b32 exec_hi, 0xff00ff
    buffer_store_short v26, v52, s[64:67], s32 offen
    s_mov_b64 exec, -1
    s_cmp_eq_u32 s29, 2
    s_cbranch_scc0 L_nonce_115
    s_cmp_eq_u32 s78, 0
    s_cbranch_scc0 L_nonce_115
    v_mov_b32 v53, s93
    s_mov_b32 exec_lo, 0x1
    s_mov_b32 exec_hi, 0x0
    buffer_store_dword v53, off, s[36:39], 0 offset:0 sc1
    s_mov_b64 exec, -1
L_nonce_115:
L_fin_114:
L_END:
    s_endpgm
L_sts_58:
    buffer_store_dwordx4 v[32:35], v57, s[36:39], s90 offen sc1
    s_branch L_stb_59
L_sts_61:
    buffer_store_dwordx4 v[48:51], off, s[36:39], s91 sc1
    s_branch L_stb_62
.section .rodata,"a"
.p2align 6
.amdhsa_kernel interleave_layers__sliding_block_cached__glu_gated_bilinear__decode_kernel
  .amdhsa_next_free_vgpr 256
  .amdhsa_next_free_sgpr 102
  .amdhsa_accum_offset 256
  .amdhsa_group_segment_fixed_size 0
  .amdhsa_kernarg_size 96
  .amdhsa_user_sgpr_count 2
  .amdhsa_user_sgpr_kernarg_segment_ptr 1
  .amdhsa_system_sgpr_workgroup_id_x 1
.end_amdhsa_kernel
```
